```python
import torch

def _softmax(x, axis=-1):
    return torch.softmax(x, dim=axis)
def _gelu(x):
    return torch.nn.functional.gelu(x, approximate="tanh")
def _silu(x):
    return torch.nn.functional.silu(x)
def _sigmoid(x):
    return torch.sigmoid(x)
def _layernorm(x, axis=-1, eps=1e-5):
    m = x.mean(dim=axis, keepdim=True)
    v = x.var(dim=axis, keepdim=True, unbiased=False)
    return (x - m) / torch.sqrt(v + eps)
def _scatter_add(tgt, idx, src, axis=0):
    return tgt.clone().index_add_(axis, idx, src)
def _segment_sum(src, seg, n):
    out = torch.zeros((n,) + src.shape[1:], dtype=src.dtype)
    return out.index_add_(0, seg, src)
def _pad(x, pw):
    flat = tuple(v for pair in reversed(pw) for v in pair)
    return torch.nn.functional.pad(x, flat)

kernel_name = 'gated_mix__ssm_conv_s4__mha_block__prompt'

def setup_inputs():

    _w = (lambda a: (lambda t: t.to(torch.bfloat16) if t.is_floating_point() else t)(torch.as_tensor(a)))
    def _A_setup():
        B, L, D, N = 1, 2048, 576, 128
        A_re = -(lambda _x: torch.exp(torch.as_tensor(_x)))((lambda *s: torch.randn(*s, dtype=torch.bfloat16) * 6.4)(D, N))
        A_im = torch.pi * (lambda *s: torch.randn(*s, dtype=torch.bfloat16) * 0.1)(D, N)
        B_re = (lambda *s: torch.randn(*s, dtype=torch.bfloat16) * 0.2)(D, N)
        B_im = (lambda *s: torch.randn(*s, dtype=torch.bfloat16) * 0.2)(D, N)
        C_re = (lambda *s: torch.randn(*s, dtype=torch.bfloat16) * 0.2)(D, N)
        C_im = (lambda *s: torch.randn(*s, dtype=torch.bfloat16) * 0.2)(D, N)
        log_dt = (lambda *s: torch.randn(*s, dtype=torch.bfloat16) * 0.1)(D) * 0.5 - 4.0
        Dskip = (lambda *s: torch.randn(*s, dtype=torch.bfloat16) * 0.1)(D)
        return {
            "u": _w((lambda *s: torch.randn(*s, dtype=torch.bfloat16) * 0.05)(B, L, D)),
            "A_re": _w(A_re),
            "A_im": _w(A_im),
            "B_re": _w(B_re),
            "B_im": _w(B_im),
            "C_re": _w(C_re),
            "C_im": _w(C_im),
            "log_dt": _w(log_dt),
            "Dskip": _w(Dskip),
        }
    _A_in = _A_setup()

    def _B_setup():
        B, S, D, H = 1, 2048, 576, 32
        return {
            "x": _w((lambda *s: torch.randn(*s, dtype=torch.bfloat16) * 0.05)(B, S, D)),
            "wqkv": _w((lambda *s: torch.randn(*s, dtype=torch.bfloat16) * 0.8)(D, 3 * D)),
            "wo": _w((lambda *s: torch.randn(*s, dtype=torch.bfloat16) * 0.05)(D, D)),
        }
    _B_in = _B_setup()

    return {
        "A_u": _A_in["u"],
        "A_A_re": _A_in["A_re"],
        "A_A_im": _A_in["A_im"],
        "A_B_re": _A_in["B_re"],
        "A_B_im": _A_in["B_im"],
        "A_C_re": _A_in["C_re"],
        "A_C_im": _A_in["C_im"],
        "A_log_dt": _A_in["log_dt"],
        "A_Dskip": _A_in["Dskip"],
        "B_x": _B_in["x"],
        "B_wqkv": _B_in["wqkv"],
        "B_wo": _B_in["wo"],
        "gate_w": _w((lambda *s: torch.randn(*s, dtype=torch.bfloat16) * 0.05)(576) * 16.0),
    }

def reference(A_u, A_A_re, A_A_im, A_B_re, A_B_im, A_C_re, A_C_im, A_log_dt, A_Dskip, B_x, B_wqkv, B_wo, gate_w):
    def _A_ref(u, A_re, A_im, B_re, B_im, C_re, C_im, log_dt, Dskip):
        Bsz, L, D = u.shape
        dt = torch.exp(log_dt)[:, None]
        A = A_re + 1j * A_im
        Bc = B_re + 1j * B_im
        Cc = C_re + 1j * C_im
        logdA = dt * A
        dB = dt * Bc
        l = (lambda x, dt: x.to(dt))(torch.arange(L), A_re.dtype)
        P = torch.exp(logdA[:, :, None] * l[None, None, :])
        K = torch.einsum("dn,dnl,dn->dl", Cc, P, dB).real
        L2 = 2 * L
        Kp = _pad(K, ((0, 0), (0, L)))
        up = (lambda x, *d: x.permute(*d))(u, 0, 2, 1)
        up = _pad(up, ((0, 0), (0, 0), (0, L)))
        Kf = (lambda x, axes=(-2,-1): torch.fft.rfft2(x.float(), dim=axes))(Kp[:, None, :], axes=(-2, -1))
        Uf = (lambda x, axes=(-2,-1): torch.fft.rfft2(x.float(), dim=axes))(up[:, :, None, :], axes=(-2, -1))
        Yf = Uf * Kf[None, :, :, :]
        y = (lambda x, s, axes=(-2,-1): torch.fft.irfft2(x, s=s, dim=axes).to(torch.bfloat16))(Yf, (1, L2), axes=(-2, -1))[:, :, 0, :L]
        y = (lambda x, *d: x.permute(*d))(y, 0, 2, 1) + u * Dskip[None, None, :]
        return y

    def _B_ref(x, wqkv, wo):
        B, S, D = x.shape
        H = 32
        Dh = D // H
        qkv = (lambda x, *d: x.permute(*d))((x @ wqkv).reshape(B, S, 3, H, Dh), 2, 0, 3, 1, 4)
        q, k, v = qkv[0], qkv[1], qkv[2]
        scores = torch.einsum("bhqd,bhkd->bhqk", q, k) * (Dh ** -0.5)
        p = _softmax(scores, axis=-1)
        o = torch.einsum("bhqk,bhkd->bhqd", p, v)
        return (lambda x, *d: x.permute(*d))(o, 0, 2, 1, 3).reshape(B, S, D) @ wo

    x = A_u
    g = _sigmoid((x * gate_w).sum(-1, keepdims=True))
    a = _A_ref(x, A_A_re, A_A_im, A_B_re, A_B_im, A_C_re, A_C_im, A_log_dt, A_Dskip)
    b = _B_ref(x, B_wqkv, B_wo)
    return g * a + (1 - g) * b
```

```asm
; @launch grid=(256,1,1) block=(768,1,1) lds=163840
.amdgcn_target "amdgcn-amd-amdhsa--gfx950"
.text
.globl gated_mix__ssm_conv_s4__mha_block__prompt_kernel
.p2align 8
.type gated_mix__ssm_conv_s4__mha_block__prompt_kernel,@function
gated_mix__ssm_conv_s4__mha_block__prompt_kernel:
    s_load_dwordx16 s[16:31], s[0:1], 0
    s_load_dwordx16 s[32:47], s[0:1], 64
    v_readfirstlane_b32 s3, v0
    v_and_b32 v0, 63, v0
    s_lshr_b32 s3, s3, 6
    s_cmp_ge_u32 s2, 224
    s_cbranch_scc1 L_aux
    s_lshl_b32 s99, s2, 1
    s_mov_b32 s98, 0
    s_lshr_b32 s48, s3, 2
    s_cmp_lg_u32 s48, 1
    s_cbranch_scc1 L_nk
    L_kgl:
    s_getpc_b64 s[50:51]
    L_kg_pc:
    s_add_u32 s50, s50, kgen_tab-L_kg_pc
    s_addc_u32 s51, s51, 0
    v_lshlrev_b32 v12, 4, v0
    global_load_dwordx4 v[16:19], v12, s[50:51]
    s_and_b32 s50, s3, 1
    s_add_u32 s52, s99, s50
    s_lshl_b32 s52, s52, 8
    s_and_b32 s53, s3, 2
    s_lshl_b32 s53, s53, 6
    s_add_u32 s52, s52, s53
    v_and_b32 v1, 31, v0
    v_lshl_add_u32 v2, v1, 2, s52
    s_lshl_b32 s52, s99, 1
    s_waitcnt lgkmcnt(0)
    global_load_dword v4, v2, s[18:19]
    global_load_dword v5, v2, s[20:21]
    global_load_dword v6, v2, s[22:23]
    global_load_dword v7, v2, s[24:25]
    global_load_dword v8, v2, s[26:27]
    global_load_dword v9, v2, s[28:29]
    s_load_dword s65, s[30:31], s52
    s_load_dword s66, s[32:33], s52
    s_branch L_kgen
    L_nk:
    s_cmp_lt_u32 s3, 4
    s_cbranch_scc1 L_gemm
    s_cmp_lg_u32 s3, 10
    s_cbranch_scc1 L_nt
    s_setprio 3
    s_and_b32 s50, s2, 7
    s_bfe_u32 s51, s2, 0x20003
    s_lshl2_add_u32 s50, s50, s51
    s_lshr_b32 s51, s2, 5
    s_mul_i32 s52, s50, 73728
    s_lshl_b32 s53, s51, 7
    s_add_u32 s53, s52, s53
    v_lshrrev_b32 v1, 3, v0
    v_mul_u32_u24 v2, 1152, v1
    v_and_b32 v4, 7, v0
    v_lshl_add_u32 v2, v4, 4, v2
    v_and_b32 v3, 16, v0
    v_lshlrev_b32 v3, 2, v3
    v_xor_b32 v2, v2, v3
    s_mov_b32 m0, 131072
    s_mov_b32 s6, 2359296
    s_mov_b32 s7, 0x00020000
    s_waitcnt lgkmcnt(0)
    s_mov_b64 s[4:5], s[16:17]
    buffer_load_dwordx4 v2, s[4:7], s53 offen offset:0 lds
    s_add_u32 s53, s53, 8192
    buffer_load_dwordx4 v2, s[4:7], s53 offen offset:1024 lds
    s_add_u32 s53, s53, 8192
    buffer_load_dwordx4 v2, s[4:7], s53 offen offset:2048 lds
    s_add_u32 s53, s53, 8192
    buffer_load_dwordx4 v2, s[4:7], s53 offen offset:3072 lds
    s_add_u32 s53, s53, 8192
    s_mov_b32 m0, 135168
    s_add_u32 s53, s53, 4096
    buffer_load_dwordx4 v2, s[4:7], s53 offen offset:0 lds
    s_add_u32 s53, s53, 8192
    buffer_load_dwordx4 v2, s[4:7], s53 offen offset:1024 lds
    s_add_u32 s53, s53, 8192
    buffer_load_dwordx4 v2, s[4:7], s53 offen offset:2048 lds
    s_add_u32 s53, s53, 8192
    buffer_load_dwordx4 v2, s[4:7], s53 offen offset:3072 lds
    s_branch L_tru
    L_nt:
    s_cmp_eq_u32 s3, 11
    s_cbranch_scc1 L_util
    s_setprio 3
    v_lshrrev_b32 v2, 4, v0
    s_bfe_u32 s50, s2, 0x10003
    s_bfe_u32 s51, s2, 0x10005
    s_xor_b32 s50, s50, s51
    s_mov_b32 s50, 0x13023120
    s_cmov_b32 s50, 0x57467564
    s_lshl_b32 s51, s2, 2
    s_lshr_b32 s50, s50, s51
    s_and_b32 s50, s50, 15
    s_mov_b32 s7, 0x00020000
    s_mov_b32 s52, 0x18000
    s_mov_b32 s53, 0
    s_cmp_eq_u32 s3, 9
    s_cbranch_scc1 L_ld_w
    s_and_b32 s48, s2, 6
    s_lshl_b32 s48, s48, 8
    s_and_b32 s49, s2, 0x18
    s_lshl_b32 s49, s49, 4
    s_add_u32 s48, s48, s49
    v_lshrrev_b32 v1, 3, v0
    v_add_u32 v1, s48, v1
    v_mul_u32_u24 v1, 1152, v1
    v_and_b32 v3, 7, v0
    v_xor_b32 v3, v3, v2
    v_lshl_add_u32 v4, v3, 4, v1
    v_xor_b32 v5, 64, v4
    v_add_u32 v5, 8192, v5
    s_movk_i32 s57, 128
    s_mov_b32 s58, 36864
    s_mov_b32 s6, 2359296
    s_mov_b32 s51, 0
    s_movk_i32 s49, 16384
    s_branch L_ld_go
    L_ld_w:
    s_and_b32 s48, s2, 1
    s_mul_i32 s48, s48, 7
    s_lshr_b32 s49, s2, 5
    s_add_u32 s48, s48, s49
    s_lshl_b32 s48, s48, 8
    v_mul_u32_u24 v1, 3456, v2
    v_and_b32 v3, 15, v0
    v_lshlrev_b32 v2, 2, v2
    v_xor_b32 v3, v3, v2
    v_lshl_add_u32 v1, v3, 4, v1
    v_add_u32 v4, s48, v1
    v_add_u32 v5, 12800, v4
    s_mov_b32 s57, 221184
    s_mov_b32 s58, 55296
    s_mov_b32 s6, 1990656
    s_movk_i32 s51, 16384
    s_movk_i32 s49, 25600
    L_ld_go:
    v_add_u32 v6, s49, v4
    v_add_u32 v7, s49, v5
    s_mul_i32 s50, s50, s57
    s_mul_i32 s59, s57, 9
    s_cmp_eq_u32 s3, 9
    s_waitcnt lgkmcnt(0)
    s_cselect_b64 s[4:5], s[36:37], s[16:17]
    L_ld_loop:
    s_mov_b32 m0, s51
    s_add_u32 s54, s50, s58
    buffer_load_dwordx4 v4, s[4:7], s50 offen offset:0  lds
    buffer_load_dwordx4 v5, s[4:7], s50 offen offset:1024  lds
    buffer_load_dwordx4 v6, s[4:7], s50 offen offset:2048  lds
    buffer_load_dwordx4 v7, s[4:7], s50 offen offset:3072  lds
    s_add_u32 m0, s51, 4096
    s_add_u32 s55, s54, s58
    buffer_load_dwordx4 v4, s[4:7], s54 offen offset:0  lds
    buffer_load_dwordx4 v5, s[4:7], s54 offen offset:1024  lds
    buffer_load_dwordx4 v6, s[4:7], s54 offen offset:2048  lds
    buffer_load_dwordx4 v7, s[4:7], s54 offen offset:3072  lds
    s_add_u32 m0, s51, 8192
    s_add_u32 s56, s55, s58
    buffer_load_dwordx4 v4, s[4:7], s55 offen offset:0  lds
    buffer_load_dwordx4 v5, s[4:7], s55 offen offset:1024  lds
    buffer_load_dwordx4 v6, s[4:7], s55 offen offset:2048  lds
    buffer_load_dwordx4 v7, s[4:7], s55 offen offset:3072  lds
    s_add_u32 m0, s51, 12288
    s_add_u32 s50, s50, s57
    s_cmp_eq_u32 s50, s59
    s_cselect_b32 s50, 0, s50
    buffer_load_dwordx4 v4, s[4:7], s56 offen offset:0  lds
    buffer_load_dwordx4 v5, s[4:7], s56 offen offset:1024  lds
    buffer_load_dwordx4 v6, s[4:7], s56 offen offset:2048  lds
    buffer_load_dwordx4 v7, s[4:7], s56 offen offset:3072  lds
    s_xor_b32 s51, s51, s52
    s_xor_b32 s52, s52, 0x10000
    s_add_u32 s53, s53, 1
    s_cmp_lt_u32 s53, 2
    s_cbranch_scc1 L_ld_loop
    s_waitcnt vmcnt(16)
    s_barrier
    s_cmp_lt_u32 s53, 9
    s_cbranch_scc1 L_ld_loop
    s_mov_b32 s12, s46
    s_mov_b32 s13, s47
    s_mov_b32 s14, 17766528
    s_mov_b32 s15, 0x00020000
    s_add_u32 s100, s46, 17651712
    s_addc_u32 s101, s47, 0
    s_load_dword s70, s[100:101], 0
    s_waitcnt vmcnt(0)
    s_barrier
    s_waitcnt lgkmcnt(0)
    s_mul_i32 s70, s70, 0x9e3779b1
    s_add_u32 s70, s70, 0x7f4a7c15
    s_branch L_kv
    L_tru:
    s_mov_b32 s49, 131072
    s_mov_b32 s12, s46
    s_mov_b32 s13, s47
    s_mov_b32 s14, 17766528
    s_mov_b32 s15, 0x00020000
    s_add_u32 s100, s46, 17651712
    s_addc_u32 s101, s47, 0
    s_load_dword s70, s[100:101], 0
    v_bfe_u32 v3, v0, 2, 2
    v_and_b32 v5, 1, v0
    v_lshl_add_u32 v3, v5, 5, v3
    v_lshlrev_b32 v3, 7, v3
    v_and_b32 v5, 0x30, v0
    v_add_u32 v3, v3, v5
    v_bfe_u32 v5, v0, 1, 1
    v_lshl_add_u32 v3, v5, 3, v3
    v_bfe_u32 v5, v0, 3, 1
    v_lshl_add_u32 v3, v5, 6, v3
    v_add_u32 v5, s49, v3
    v_xor_b32 v6, 64, v5
    v_mul_u32_u24 v2, 16896, v1
    v_lshl_add_u32 v2, v4, 4, v2
    s_mul_i32 s52, s51, 270336
    s_add_u32 s52, s52, 7110656
    s_lshl_b32 s54, s51, 5
    s_add_u32 s54, s54, s50
    s_mul_i32 s54, s54, 128
    s_add_u32 s54, s54, 17301504
    s_lshl_b32 s53, s50, 7
    s_add_u32 s55, s52, s53
    s_mov_b32 s56, 0
    s_waitcnt lgkmcnt(0)
    s_mul_i32 s70, s70, 0x9e3779b1
    s_add_u32 s70, s70, 0x7f4a7c15
    L_tu_loop:
    ds_read_b64_tr_b16 v[8:9], v5 offset:0
    ds_read_b64_tr_b16 v[10:11], v5 offset:512
    ds_read_b64_tr_b16 v[12:13], v5 offset:1024
    ds_read_b64_tr_b16 v[14:15], v5 offset:1536
    ds_read_b64_tr_b16 v[16:17], v5 offset:2048
    ds_read_b64_tr_b16 v[18:19], v5 offset:2560
    ds_read_b64_tr_b16 v[20:21], v5 offset:3072
    ds_read_b64_tr_b16 v[22:23], v5 offset:3584
    ds_read_b64_tr_b16 v[24:25], v6 offset:0
    ds_read_b64_tr_b16 v[26:27], v6 offset:512
    ds_read_b64_tr_b16 v[28:29], v6 offset:1024
    ds_read_b64_tr_b16 v[30:31], v6 offset:1536
    ds_read_b64_tr_b16 v[32:33], v6 offset:2048
    ds_read_b64_tr_b16 v[34:35], v6 offset:2560
    ds_read_b64_tr_b16 v[36:37], v6 offset:3072
    ds_read_b64_tr_b16 v[38:39], v6 offset:3584
    s_waitcnt lgkmcnt(0)
    s_mov_b32 vcc_lo, 0x55555555
    s_mov_b32 vcc_hi, 0x55555555
    v_cndmask_b32_dpp v40, v12, v8, vcc quad_perm:[1,0,3,2] row_mask:0xf bank_mask:0xf
    v_cndmask_b32_dpp v41, v13, v9, vcc quad_perm:[1,0,3,2] row_mask:0xf bank_mask:0xf
    v_cndmask_b32_dpp v42, v14, v10, vcc quad_perm:[1,0,3,2] row_mask:0xf bank_mask:0xf
    v_cndmask_b32_dpp v43, v15, v11, vcc quad_perm:[1,0,3,2] row_mask:0xf bank_mask:0xf
    v_cndmask_b32_dpp v48, v20, v16, vcc quad_perm:[1,0,3,2] row_mask:0xf bank_mask:0xf
    v_cndmask_b32_dpp v49, v21, v17, vcc quad_perm:[1,0,3,2] row_mask:0xf bank_mask:0xf
    v_cndmask_b32_dpp v50, v22, v18, vcc quad_perm:[1,0,3,2] row_mask:0xf bank_mask:0xf
    v_cndmask_b32_dpp v51, v23, v19, vcc quad_perm:[1,0,3,2] row_mask:0xf bank_mask:0xf
    v_cndmask_b32_dpp v56, v28, v24, vcc quad_perm:[1,0,3,2] row_mask:0xf bank_mask:0xf
    v_cndmask_b32_dpp v57, v29, v25, vcc quad_perm:[1,0,3,2] row_mask:0xf bank_mask:0xf
    v_cndmask_b32_dpp v58, v30, v26, vcc quad_perm:[1,0,3,2] row_mask:0xf bank_mask:0xf
    v_cndmask_b32_dpp v59, v31, v27, vcc quad_perm:[1,0,3,2] row_mask:0xf bank_mask:0xf
    v_cndmask_b32_dpp v64, v36, v32, vcc quad_perm:[1,0,3,2] row_mask:0xf bank_mask:0xf
    v_cndmask_b32_dpp v65, v37, v33, vcc quad_perm:[1,0,3,2] row_mask:0xf bank_mask:0xf
    v_cndmask_b32_dpp v66, v38, v34, vcc quad_perm:[1,0,3,2] row_mask:0xf bank_mask:0xf
    v_cndmask_b32_dpp v67, v39, v35, vcc quad_perm:[1,0,3,2] row_mask:0xf bank_mask:0xf
    s_mov_b32 vcc_lo, 0xaaaaaaaa
    s_mov_b32 vcc_hi, 0xaaaaaaaa
    v_cndmask_b32_dpp v44, v8, v12, vcc quad_perm:[1,0,3,2] row_mask:0xf bank_mask:0xf
    v_cndmask_b32_dpp v45, v9, v13, vcc quad_perm:[1,0,3,2] row_mask:0xf bank_mask:0xf
    v_cndmask_b32_dpp v46, v10, v14, vcc quad_perm:[1,0,3,2] row_mask:0xf bank_mask:0xf
    v_cndmask_b32_dpp v47, v11, v15, vcc quad_perm:[1,0,3,2] row_mask:0xf bank_mask:0xf
    v_cndmask_b32_dpp v52, v16, v20, vcc quad_perm:[1,0,3,2] row_mask:0xf bank_mask:0xf
    v_cndmask_b32_dpp v53, v17, v21, vcc quad_perm:[1,0,3,2] row_mask:0xf bank_mask:0xf
    v_cndmask_b32_dpp v54, v18, v22, vcc quad_perm:[1,0,3,2] row_mask:0xf bank_mask:0xf
    v_cndmask_b32_dpp v55, v19, v23, vcc quad_perm:[1,0,3,2] row_mask:0xf bank_mask:0xf
    v_cndmask_b32_dpp v60, v24, v28, vcc quad_perm:[1,0,3,2] row_mask:0xf bank_mask:0xf
    v_cndmask_b32_dpp v61, v25, v29, vcc quad_perm:[1,0,3,2] row_mask:0xf bank_mask:0xf
    v_cndmask_b32_dpp v62, v26, v30, vcc quad_perm:[1,0,3,2] row_mask:0xf bank_mask:0xf
    v_cndmask_b32_dpp v63, v27, v31, vcc quad_perm:[1,0,3,2] row_mask:0xf bank_mask:0xf
    v_cndmask_b32_dpp v68, v32, v36, vcc quad_perm:[1,0,3,2] row_mask:0xf bank_mask:0xf
    v_cndmask_b32_dpp v69, v33, v37, vcc quad_perm:[1,0,3,2] row_mask:0xf bank_mask:0xf
    v_cndmask_b32_dpp v70, v34, v38, vcc quad_perm:[1,0,3,2] row_mask:0xf bank_mask:0xf
    v_cndmask_b32_dpp v71, v35, v39, vcc quad_perm:[1,0,3,2] row_mask:0xf bank_mask:0xf
    s_mov_b32 vcc_lo, 0x33333333
    s_mov_b32 vcc_hi, 0x33333333
    v_cndmask_b32_dpp v8, v48, v40, vcc quad_perm:[2,3,0,1] row_mask:0xf bank_mask:0xf
    v_cndmask_b32_dpp v9, v49, v41, vcc quad_perm:[2,3,0,1] row_mask:0xf bank_mask:0xf
    v_cndmask_b32_dpp v10, v50, v42, vcc quad_perm:[2,3,0,1] row_mask:0xf bank_mask:0xf
    v_cndmask_b32_dpp v11, v51, v43, vcc quad_perm:[2,3,0,1] row_mask:0xf bank_mask:0xf
    v_cndmask_b32_dpp v12, v52, v44, vcc quad_perm:[2,3,0,1] row_mask:0xf bank_mask:0xf
    v_cndmask_b32_dpp v13, v53, v45, vcc quad_perm:[2,3,0,1] row_mask:0xf bank_mask:0xf
    v_cndmask_b32_dpp v14, v54, v46, vcc quad_perm:[2,3,0,1] row_mask:0xf bank_mask:0xf
    v_cndmask_b32_dpp v15, v55, v47, vcc quad_perm:[2,3,0,1] row_mask:0xf bank_mask:0xf
    v_cndmask_b32_dpp v24, v64, v56, vcc quad_perm:[2,3,0,1] row_mask:0xf bank_mask:0xf
    v_cndmask_b32_dpp v25, v65, v57, vcc quad_perm:[2,3,0,1] row_mask:0xf bank_mask:0xf
    v_cndmask_b32_dpp v26, v66, v58, vcc quad_perm:[2,3,0,1] row_mask:0xf bank_mask:0xf
    v_cndmask_b32_dpp v27, v67, v59, vcc quad_perm:[2,3,0,1] row_mask:0xf bank_mask:0xf
    v_cndmask_b32_dpp v28, v68, v60, vcc quad_perm:[2,3,0,1] row_mask:0xf bank_mask:0xf
    v_cndmask_b32_dpp v29, v69, v61, vcc quad_perm:[2,3,0,1] row_mask:0xf bank_mask:0xf
    v_cndmask_b32_dpp v30, v70, v62, vcc quad_perm:[2,3,0,1] row_mask:0xf bank_mask:0xf
    v_cndmask_b32_dpp v31, v71, v63, vcc quad_perm:[2,3,0,1] row_mask:0xf bank_mask:0xf
    s_mov_b32 vcc_lo, 0xcccccccc
    s_mov_b32 vcc_hi, 0xcccccccc
    v_cndmask_b32_dpp v16, v40, v48, vcc quad_perm:[2,3,0,1] row_mask:0xf bank_mask:0xf
    v_cndmask_b32_dpp v17, v41, v49, vcc quad_perm:[2,3,0,1] row_mask:0xf bank_mask:0xf
    v_cndmask_b32_dpp v18, v42, v50, vcc quad_perm:[2,3,0,1] row_mask:0xf bank_mask:0xf
    v_cndmask_b32_dpp v19, v43, v51, vcc quad_perm:[2,3,0,1] row_mask:0xf bank_mask:0xf
    v_cndmask_b32_dpp v20, v44, v52, vcc quad_perm:[2,3,0,1] row_mask:0xf bank_mask:0xf
    v_cndmask_b32_dpp v21, v45, v53, vcc quad_perm:[2,3,0,1] row_mask:0xf bank_mask:0xf
    v_cndmask_b32_dpp v22, v46, v54, vcc quad_perm:[2,3,0,1] row_mask:0xf bank_mask:0xf
    v_cndmask_b32_dpp v23, v47, v55, vcc quad_perm:[2,3,0,1] row_mask:0xf bank_mask:0xf
    v_cndmask_b32_dpp v32, v56, v64, vcc quad_perm:[2,3,0,1] row_mask:0xf bank_mask:0xf
    v_cndmask_b32_dpp v33, v57, v65, vcc quad_perm:[2,3,0,1] row_mask:0xf bank_mask:0xf
    v_cndmask_b32_dpp v34, v58, v66, vcc quad_perm:[2,3,0,1] row_mask:0xf bank_mask:0xf
    v_cndmask_b32_dpp v35, v59, v67, vcc quad_perm:[2,3,0,1] row_mask:0xf bank_mask:0xf
    v_cndmask_b32_dpp v36, v60, v68, vcc quad_perm:[2,3,0,1] row_mask:0xf bank_mask:0xf
    v_cndmask_b32_dpp v37, v61, v69, vcc quad_perm:[2,3,0,1] row_mask:0xf bank_mask:0xf
    v_cndmask_b32_dpp v38, v62, v70, vcc quad_perm:[2,3,0,1] row_mask:0xf bank_mask:0xf
    v_cndmask_b32_dpp v39, v63, v71, vcc quad_perm:[2,3,0,1] row_mask:0xf bank_mask:0xf
    s_cmp_lg_u32 s56, 0
    s_cbranch_scc1 L_tu_st
    s_mov_b32 s56, 1
    s_barrier
    s_waitcnt vmcnt(0)
    s_branch L_tu_loop
    L_tu_st:
    s_barrier
    s_add_u32 s53, s55, 0
    buffer_store_dwordx4 v[8:11], v2, s[12:15], s53 offen sc1
    s_add_u32 s53, s55, 4224
    buffer_store_dwordx4 v[12:15], v2, s[12:15], s53 offen sc1
    s_add_u32 s53, s55, 8448
    buffer_store_dwordx4 v[16:19], v2, s[12:15], s53 offen sc1
    s_add_u32 s53, s55, 12672
    buffer_store_dwordx4 v[20:23], v2, s[12:15], s53 offen sc1
    s_add_u32 s53, s55, 135168
    buffer_store_dwordx4 v[24:27], v2, s[12:15], s53 offen sc1
    s_add_u32 s53, s55, 139392
    buffer_store_dwordx4 v[28:31], v2, s[12:15], s53 offen sc1
    s_add_u32 s53, s55, 143616
    buffer_store_dwordx4 v[32:35], v2, s[12:15], s53 offen sc1
    s_add_u32 s53, s55, 147840
    buffer_store_dwordx4 v[36:39], v2, s[12:15], s53 offen sc1
    s_barrier
    s_barrier
    s_waitcnt vmcnt(0)
    v_mov_b32 v72, s70
    v_lshlrev_b32 v73, 2, v0
    s_mov_b32 exec_hi, 0
    buffer_store_dword v72, v73, s[12:15], s54 offen sc1
    s_mov_b64 exec, -1
    s_branch L_kv
L_gemm:
    s_and_b32 s53, s2, 7
    s_lshr_b32 s54, s2, 3
    s_lshr_b32 s55, s53, 1
    s_lshl_b32 s55, s55, 2
    s_and_b32 s56, s54, 3
    s_add_u32 s48, s55, s56
    s_and_b32 s53, s53, 1
    s_mul_i32 s53, s53, 7
    s_lshr_b32 s54, s54, 2
    s_add_u32 s49, s53, s54
    s_and_b32 s53, s3, 1
    s_lshr_b32 s54, s3, 1
    s_lshl_b32 s55, s53, 13
    v_and_b32 v1, 31, v0
    v_lshlrev_b32 v1, 7, v1
    v_add_u32 v1, s55, v1
    v_lshrrev_b32 v2, 5, v0
    v_bfe_u32 v3, v0, 1, 3
    v_xor_b32 v3, v3, v2
    v_lshl_add_u32 v4, v3, 4, v1
    v_xor_b32 v5, 32, v4
    v_xor_b32 v6, 0x40040, v4
    v_xor_b32 v7, 0x40060, v4
    v_bfe_u32 v1, v0, 2, 2
    v_lshl_add_u32 v3, v2, 3, v1
    v_lshlrev_b32 v3, 8, v3
    s_lshl_b32 s55, s54, 1
    v_xor_b32 v1, s55, v1
    v_lshl_add_u32 v3, v1, 6, v3
    v_bfe_u32 v1, v0, 4, 1
    v_lshl_add_u32 v3, v1, 5, v3
    v_and_b32 v1, 3, v0
    v_lshl_add_u32 v3, v1, 3, v3
    v_add_u32 v8, 0x44000, v3
    v_xor_b32 v9, 64, v8
    v_mov_b32 v10, 157696
    s_lshl_b32 s56, s48, 1
    s_add_u32 s56, s56, s53
    s_lshl_b32 s57, s49, 1
    s_add_u32 s57, s57, s54
    s_waitcnt lgkmcnt(0)
    s_mov_b32 s12, s46
    s_mov_b32 s13, s47
    s_mov_b32 s14, 17766528
    s_mov_b32 s15, 0x00020000
    s_add_u32 s100, s46, 17651712
    s_addc_u32 s101, s47, 0
    s_load_dword s70, s[100:101], 0
    s_waitcnt lgkmcnt(0)
    s_mul_i32 s70, s70, 0x9e3779b1
    s_add_u32 s70, s70, 0x7f4a7c15
    v_mov_b32 v16, 0
    v_mov_b32 v17, 0
    v_mov_b32 v18, 0
    v_mov_b32 v19, 0
    v_mov_b32 v20, 0
    v_mov_b32 v21, 0
    v_mov_b32 v22, 0
    v_mov_b32 v23, 0
    v_mov_b32 v24, 0
    v_mov_b32 v25, 0
    v_mov_b32 v26, 0
    v_mov_b32 v27, 0
    v_mov_b32 v28, 0
    v_mov_b32 v29, 0
    v_mov_b32 v30, 0
    v_mov_b32 v31, 0
    v_mov_b32 v32, 0
    v_mov_b32 v33, 0
    v_mov_b32 v34, 0
    v_mov_b32 v35, 0
    v_mov_b32 v36, 0
    v_mov_b32 v37, 0
    v_mov_b32 v38, 0
    v_mov_b32 v39, 0
    v_mov_b32 v40, 0
    v_mov_b32 v41, 0
    v_mov_b32 v42, 0
    v_mov_b32 v43, 0
    v_mov_b32 v44, 0
    v_mov_b32 v45, 0
    v_mov_b32 v46, 0
    v_mov_b32 v47, 0
    v_mov_b32 v80, 0
    v_mov_b32 v81, 0
    v_mov_b32 v82, 0
    v_mov_b32 v83, 0
    v_mov_b32 v84, 0
    v_mov_b32 v85, 0
    v_mov_b32 v86, 0
    v_mov_b32 v87, 0
    v_mov_b32 v88, 0
    v_mov_b32 v89, 0
    v_mov_b32 v90, 0
    v_mov_b32 v91, 0
    v_mov_b32 v92, 0
    v_mov_b32 v93, 0
    v_mov_b32 v94, 0
    v_mov_b32 v95, 0
    v_mov_b32 v96, 0
    v_mov_b32 v97, 0
    v_mov_b32 v98, 0
    v_mov_b32 v99, 0
    v_mov_b32 v100, 0
    v_mov_b32 v101, 0
    v_mov_b32 v102, 0
    v_mov_b32 v103, 0
    v_mov_b32 v104, 0
    v_mov_b32 v105, 0
    v_mov_b32 v106, 0
    v_mov_b32 v107, 0
    v_mov_b32 v108, 0
    v_mov_b32 v109, 0
    v_mov_b32 v110, 0
    v_mov_b32 v111, 0
    v_mov_b32 v112, 0
    v_mov_b32 v113, 0
    v_mov_b32 v114, 0
    v_mov_b32 v115, 0
    v_mov_b32 v116, 0
    v_mov_b32 v117, 0
    v_mov_b32 v118, 0
    v_mov_b32 v119, 0
    v_mov_b32 v120, 0
    v_mov_b32 v121, 0
    v_mov_b32 v122, 0
    v_mov_b32 v123, 0
    v_mov_b32 v124, 0
    v_mov_b32 v125, 0
    v_mov_b32 v126, 0
    v_mov_b32 v127, 0
    v_mov_b32 v128, 0
    v_mov_b32 v129, 0
    v_mov_b32 v130, 0
    v_mov_b32 v131, 0
    v_mov_b32 v132, 0
    v_mov_b32 v133, 0
    v_mov_b32 v134, 0
    v_mov_b32 v135, 0
    v_mov_b32 v136, 0
    v_mov_b32 v137, 0
    v_mov_b32 v138, 0
    v_mov_b32 v139, 0
    v_mov_b32 v140, 0
    v_mov_b32 v141, 0
    v_mov_b32 v142, 0
    v_mov_b32 v143, 0
    s_setprio 2
    s_mov_b32 s62, 0
    s_mov_b32 s63, 0x40000
    s_mov_b32 s64, 0x18000
    s_lshl_b32 s65, s57, 5
    s_add_u32 s65, s65, s56
    s_mul_i32 s65, s65, 128
    s_add_u32 s65, s65, 17651840
    v_mov_b32 v11, 1
    v_mov_b32 v12, s70
    v_lshlrev_b32 v13, 2, v0
    s_cmp_eq_u32 s57, 27
    s_cbranch_scc1 L_g_gate
    s_cmp_ge_u32 s49, 9
    s_cbranch_scc1 L_g_vtype
    s_mul_i32 s58, s56, 147456
    s_lshl_b32 s59, s57, 12
    s_add_u32 s58, s58, s59
    s_add_u32 s59, s58, 73728
    s_mov_b32 s60, 0x3eae1a93
    s_mov_b32 s61, s60
    v_and_b32 v1, 15, v0
    v_lshlrev_b32 v1, 4, v1
    v_bfe_u32 v3, v0, 4, 1
    v_lshl_or_b32 v1, v3, 9, v1
    v_lshl_or_b32 v1, v2, 8, v1
.p2align 6
L_gm1:
    s_waitcnt lgkmcnt(6)
    v_mfma_f32_32x32x16_bf16 v[80:95], v[24:27], v[16:19], v[80:95]
    ds_read_b128 v[48:51], v6 offset:0
    ds_read_b128 v[52:55], v6 offset:4096
    v_mfma_f32_32x32x16_bf16 v[96:111], v[28:31], v[16:19], v[96:111]
    ds_read_b64_tr_b16 v[56:57], v8 offset:8192
    ds_read_b64_tr_b16 v[58:59], v8 offset:9216
    v_mfma_f32_32x32x16_bf16 v[112:127], v[24:27], v[20:23], v[112:127]
    ds_read_b64_tr_b16 v[60:61], v9 offset:8192
    ds_read_b64_tr_b16 v[62:63], v9 offset:9216
    v_mfma_f32_32x32x16_bf16 v[128:143], v[28:31], v[20:23], v[128:143]
    v_xor_b32 v6, s63, v6
    s_waitcnt lgkmcnt(6)
    v_mfma_f32_32x32x16_bf16 v[80:95], v[40:43], v[32:35], v[80:95]
    ds_read_b128 v[64:67], v7 offset:0
    ds_read_b128 v[68:71], v7 offset:4096
    v_mfma_f32_32x32x16_bf16 v[96:111], v[44:47], v[32:35], v[96:111]
    ds_read_b64_tr_b16 v[72:73], v8 offset:12288
    ds_read_b64_tr_b16 v[74:75], v8 offset:13312
    v_mfma_f32_32x32x16_bf16 v[112:127], v[40:43], v[36:39], v[112:127]
    ds_read_b64_tr_b16 v[76:77], v9 offset:12288
    ds_read_b64_tr_b16 v[78:79], v9 offset:13312
    s_cmp_eq_u32 s62, 9
    v_mfma_f32_32x32x16_bf16 v[128:143], v[44:47], v[36:39], v[128:143]
    v_xor_b32 v7, s63, v7
    v_xor_b32 v8, s63, v8
    v_xor_b32 v9, s63, v9
    s_waitcnt lgkmcnt(6)
    v_mfma_f32_32x32x16_bf16 v[80:95], v[56:59], v[48:51], v[80:95]
    s_cbranch_scc1 L_g_qk
    s_barrier
    ds_read_b128 v[16:19], v4 offset:0
    ds_read_b128 v[20:23], v4 offset:4096
    v_mfma_f32_32x32x16_bf16 v[96:111], v[60:63], v[48:51], v[96:111]
    ds_read_b64_tr_b16 v[24:25], v8 offset:0
    ds_read_b64_tr_b16 v[26:27], v8 offset:1024
    v_mfma_f32_32x32x16_bf16 v[112:127], v[56:59], v[52:55], v[112:127]
    ds_read_b64_tr_b16 v[28:29], v9 offset:0
    ds_read_b64_tr_b16 v[30:31], v9 offset:1024
    v_mfma_f32_32x32x16_bf16 v[128:143], v[60:63], v[52:55], v[128:143]
    v_xor_b32 v4, s64, v4
    s_waitcnt lgkmcnt(6)
    v_mfma_f32_32x32x16_bf16 v[80:95], v[72:75], v[64:67], v[80:95]
    ds_read_b128 v[32:35], v5 offset:0
    ds_read_b128 v[36:39], v5 offset:4096
    v_mfma_f32_32x32x16_bf16 v[96:111], v[76:79], v[64:67], v[96:111]
    ds_read_b64_tr_b16 v[40:41], v8 offset:4096
    ds_read_b64_tr_b16 v[42:43], v8 offset:5120
    s_add_u32 s62, s62, 1
    v_mfma_f32_32x32x16_bf16 v[112:127], v[72:75], v[68:71], v[112:127]
    ds_read_b64_tr_b16 v[44:45], v9 offset:4096
    ds_read_b64_tr_b16 v[46:47], v9 offset:5120
    v_xor_b32 v5, s64, v5
    s_mov_b32 s63, s64
    s_xor_b32 s64, s64, 0x10000
    v_mfma_f32_32x32x16_bf16 v[128:143], v[76:79], v[68:71], v[128:143]
    s_branch L_gm1
    L_g_qk:
    s_cmp_ge_u32 s57, 9
    s_cbranch_scc1 L_g_k
    s_waitcnt lgkmcnt(0)
    v_mfma_f32_32x32x16_bf16 v[80:95], v[72:75], v[64:67], v[80:95]
    s_nop 4
    v_mfma_f32_32x32x16_bf16 v[96:111], v[60:63], v[48:51], v[96:111]
    s_nop 4
    v_mfma_f32_32x32x16_bf16 v[96:111], v[76:79], v[64:67], v[96:111]
    v_mul_f32 v80, s60, v80
    v_mul_f32 v81, s60, v81
    v_mul_f32 v82, s60, v82
    v_mul_f32 v83, s60, v83
    v_mul_f32 v84, s60, v84
    v_mfma_f32_32x32x16_bf16 v[112:127], v[56:59], v[52:55], v[112:127]
    v_mul_f32 v85, s60, v85
    v_mul_f32 v86, s60, v86
    v_mul_f32 v87, s60, v87
    v_cvt_pk_bf16_f32 v80, v80, v81
    v_cvt_pk_bf16_f32 v81, v82, v83
    v_mfma_f32_32x32x16_bf16 v[112:127], v[72:75], v[68:71], v[112:127]
    v_cvt_pk_bf16_f32 v82, v84, v85
    v_cvt_pk_bf16_f32 v83, v86, v87
    v_mul_f32 v88, s60, v88
    v_mul_f32 v89, s60, v89
    v_mul_f32 v90, s60, v90
    v_mfma_f32_32x32x16_bf16 v[128:143], v[60:63], v[52:55], v[128:143]
    v_mul_f32 v91, s60, v91
    v_mul_f32 v92, s60, v92
    v_mul_f32 v93, s60, v93
    v_mul_f32 v94, s60, v94
    v_mul_f32 v95, s60, v95
    v_mfma_f32_32x32x16_bf16 v[128:143], v[76:79], v[68:71], v[128:143]
    v_cvt_pk_bf16_f32 v84, v88, v89
    v_cvt_pk_bf16_f32 v85, v90, v91
    v_cvt_pk_bf16_f32 v86, v92, v93
    v_cvt_pk_bf16_f32 v87, v94, v95
    v_permlane16_swap_b32 v80, v82
    v_permlane16_swap_b32 v81, v83
    v_permlane16_swap_b32 v84, v86
    v_permlane16_swap_b32 v85, v87
    buffer_store_dwordx4 v[80:83], v1, s[12:15], s58 offen offset:0 sc1
    buffer_store_dwordx4 v[84:87], v1, s[12:15], s58 offen offset:1024 sc1
    v_pk_mul_f32 v[96:97], v[96:97], s[60:61]
    v_pk_mul_f32 v[98:99], v[98:99], s[60:61]
    v_pk_mul_f32 v[100:101], v[100:101], s[60:61]
    v_pk_mul_f32 v[102:103], v[102:103], s[60:61]
    v_cvt_pk_bf16_f32 v96, v96, v97
    v_cvt_pk_bf16_f32 v97, v98, v99
    v_cvt_pk_bf16_f32 v98, v100, v101
    v_cvt_pk_bf16_f32 v99, v102, v103
    v_pk_mul_f32 v[104:105], v[104:105], s[60:61]
    v_pk_mul_f32 v[106:107], v[106:107], s[60:61]
    v_pk_mul_f32 v[108:109], v[108:109], s[60:61]
    v_pk_mul_f32 v[110:111], v[110:111], s[60:61]
    v_cvt_pk_bf16_f32 v100, v104, v105
    v_cvt_pk_bf16_f32 v101, v106, v107
    v_cvt_pk_bf16_f32 v102, v108, v109
    v_cvt_pk_bf16_f32 v103, v110, v111
    v_permlane16_swap_b32 v96, v98
    v_permlane16_swap_b32 v97, v99
    v_permlane16_swap_b32 v100, v102
    v_permlane16_swap_b32 v101, v103
    buffer_store_dwordx4 v[96:99], v1, s[12:15], s58 offen offset:2048 sc1
    buffer_store_dwordx4 v[100:103], v1, s[12:15], s58 offen offset:3072 sc1
    v_pk_mul_f32 v[112:113], v[112:113], s[60:61]
    v_pk_mul_f32 v[114:115], v[114:115], s[60:61]
    v_pk_mul_f32 v[116:117], v[116:117], s[60:61]
    v_pk_mul_f32 v[118:119], v[118:119], s[60:61]
    v_cvt_pk_bf16_f32 v112, v112, v113
    v_cvt_pk_bf16_f32 v113, v114, v115
    v_cvt_pk_bf16_f32 v114, v116, v117
    v_cvt_pk_bf16_f32 v115, v118, v119
    v_pk_mul_f32 v[120:121], v[120:121], s[60:61]
    v_pk_mul_f32 v[122:123], v[122:123], s[60:61]
    v_pk_mul_f32 v[124:125], v[124:125], s[60:61]
    v_pk_mul_f32 v[126:127], v[126:127], s[60:61]
    v_cvt_pk_bf16_f32 v116, v120, v121
    v_cvt_pk_bf16_f32 v117, v122, v123
    v_cvt_pk_bf16_f32 v118, v124, v125
    v_cvt_pk_bf16_f32 v119, v126, v127
    v_permlane16_swap_b32 v112, v114
    v_permlane16_swap_b32 v113, v115
    v_permlane16_swap_b32 v116, v118
    v_permlane16_swap_b32 v117, v119
    buffer_store_dwordx4 v[112:115], v1, s[12:15], s59 offen offset:0 sc1
    buffer_store_dwordx4 v[116:119], v1, s[12:15], s59 offen offset:1024 sc1
    v_pk_mul_f32 v[128:129], v[128:129], s[60:61]
    v_pk_mul_f32 v[130:131], v[130:131], s[60:61]
    v_pk_mul_f32 v[132:133], v[132:133], s[60:61]
    v_pk_mul_f32 v[134:135], v[134:135], s[60:61]
    v_cvt_pk_bf16_f32 v128, v128, v129
    v_cvt_pk_bf16_f32 v129, v130, v131
    v_cvt_pk_bf16_f32 v130, v132, v133
    v_cvt_pk_bf16_f32 v131, v134, v135
    v_pk_mul_f32 v[136:137], v[136:137], s[60:61]
    v_pk_mul_f32 v[138:139], v[138:139], s[60:61]
    v_pk_mul_f32 v[140:141], v[140:141], s[60:61]
    v_pk_mul_f32 v[142:143], v[142:143], s[60:61]
    v_cvt_pk_bf16_f32 v132, v136, v137
    v_cvt_pk_bf16_f32 v133, v138, v139
    v_cvt_pk_bf16_f32 v134, v140, v141
    v_cvt_pk_bf16_f32 v135, v142, v143
    v_permlane16_swap_b32 v128, v130
    v_permlane16_swap_b32 v129, v131
    v_permlane16_swap_b32 v132, v134
    v_permlane16_swap_b32 v133, v135
    buffer_store_dwordx4 v[128:131], v1, s[12:15], s59 offen offset:2048 sc1
    buffer_store_dwordx4 v[132:135], v1, s[12:15], s59 offen offset:3072 sc1
    s_branch L_g_pub
    L_g_k:
    s_waitcnt lgkmcnt(0)
    v_mfma_f32_32x32x16_bf16 v[80:95], v[72:75], v[64:67], v[80:95]
    s_nop 4
    v_mfma_f32_32x32x16_bf16 v[96:111], v[60:63], v[48:51], v[96:111]
    s_nop 4
    v_mfma_f32_32x32x16_bf16 v[96:111], v[76:79], v[64:67], v[96:111]
    v_cvt_pk_bf16_f32 v80, v80, v81
    v_cvt_pk_bf16_f32 v81, v82, v83
    v_cvt_pk_bf16_f32 v82, v84, v85
    v_cvt_pk_bf16_f32 v83, v86, v87
    v_cvt_pk_bf16_f32 v84, v88, v89
    v_mfma_f32_32x32x16_bf16 v[112:127], v[56:59], v[52:55], v[112:127]
    v_cvt_pk_bf16_f32 v85, v90, v91
    v_cvt_pk_bf16_f32 v86, v92, v93
    v_cvt_pk_bf16_f32 v87, v94, v95
    v_permlane16_swap_b32 v80, v82
    v_permlane16_swap_b32 v81, v83
    v_mfma_f32_32x32x16_bf16 v[112:127], v[72:75], v[68:71], v[112:127]
    v_permlane16_swap_b32 v84, v86
    v_permlane16_swap_b32 v85, v87
    buffer_store_dwordx4 v[80:83], v1, s[12:15], s58 offen offset:0 sc1
    buffer_store_dwordx4 v[84:87], v1, s[12:15], s58 offen offset:1024 sc1
    v_cvt_pk_bf16_f32 v96, v96, v97
    v_mfma_f32_32x32x16_bf16 v[128:143], v[60:63], v[52:55], v[128:143]
    v_cvt_pk_bf16_f32 v97, v98, v99
    v_cvt_pk_bf16_f32 v98, v100, v101
    v_cvt_pk_bf16_f32 v99, v102, v103
    v_cvt_pk_bf16_f32 v100, v104, v105
    v_cvt_pk_bf16_f32 v101, v106, v107
    v_mfma_f32_32x32x16_bf16 v[128:143], v[76:79], v[68:71], v[128:143]
    v_cvt_pk_bf16_f32 v102, v108, v109
    v_cvt_pk_bf16_f32 v103, v110, v111
    v_permlane16_swap_b32 v96, v98
    v_permlane16_swap_b32 v97, v99
    v_permlane16_swap_b32 v100, v102
    v_permlane16_swap_b32 v101, v103
    buffer_store_dwordx4 v[96:99], v1, s[12:15], s58 offen offset:2048 sc1
    buffer_store_dwordx4 v[100:103], v1, s[12:15], s58 offen offset:3072 sc1
    v_cvt_pk_bf16_f32 v112, v112, v113
    v_cvt_pk_bf16_f32 v113, v114, v115
    v_cvt_pk_bf16_f32 v114, v116, v117
    v_cvt_pk_bf16_f32 v115, v118, v119
    v_cvt_pk_bf16_f32 v116, v120, v121
    v_cvt_pk_bf16_f32 v117, v122, v123
    v_cvt_pk_bf16_f32 v118, v124, v125
    v_cvt_pk_bf16_f32 v119, v126, v127
    v_permlane16_swap_b32 v112, v114
    v_permlane16_swap_b32 v113, v115
    v_permlane16_swap_b32 v116, v118
    v_permlane16_swap_b32 v117, v119
    buffer_store_dwordx4 v[112:115], v1, s[12:15], s59 offen offset:0 sc1
    buffer_store_dwordx4 v[116:119], v1, s[12:15], s59 offen offset:1024 sc1
    v_cvt_pk_bf16_f32 v128, v128, v129
    v_cvt_pk_bf16_f32 v129, v130, v131
    v_cvt_pk_bf16_f32 v130, v132, v133
    v_cvt_pk_bf16_f32 v131, v134, v135
    v_cvt_pk_bf16_f32 v132, v136, v137
    v_cvt_pk_bf16_f32 v133, v138, v139
    v_cvt_pk_bf16_f32 v134, v140, v141
    v_cvt_pk_bf16_f32 v135, v142, v143
    v_permlane16_swap_b32 v128, v130
    v_permlane16_swap_b32 v129, v131
    v_permlane16_swap_b32 v132, v134
    v_permlane16_swap_b32 v133, v135
    buffer_store_dwordx4 v[128:131], v1, s[12:15], s59 offen offset:2048 sc1
    buffer_store_dwordx4 v[132:135], v1, s[12:15], s59 offen offset:3072 sc1
    s_branch L_g_pub
L_g_gate:
    s_mov_b32 s4, s40
    s_mov_b32 s5, s41
    s_mov_b32 s6, 1152
    s_mov_b32 s7, 0x00020000
    s_bfe_u32 s50, s2, 0x10003
    s_bfe_u32 s51, s2, 0x10005
    s_xor_b32 s50, s50, s51
    s_mov_b32 s50, 0x13023120
    s_cmov_b32 s50, 0x57467564
    s_lshl_b32 s51, s2, 2
    s_lshr_b32 s50, s50, s51
    s_and_b32 s50, s50, 15
    s_mul_i32 s50, s50, 128
    s_lshl_b32 s51, s53, 11
    s_add_u32 s51, s51, 158208
    s_mov_b32 m0, s51
    v_lshlrev_b32 v1, 4, v0
    buffer_load_dwordx4 v1, s[4:7], 0 offen lds
    buffer_load_dwordx4 v1, s[4:7], 0 offen offset:1024 lds
    v_lshl_add_u32 v9, v2, 4, s51
    s_waitcnt vmcnt(0)
    L_gt_loop:
    s_waitcnt lgkmcnt(3)
    v_mfma_f32_32x32x16_bf16 v[80:95], v[24:27], v[16:19], v[80:95]
    ds_read_b128 v[48:51], v6 offset:0
    ds_read_b128 v[52:55], v6 offset:4096
    ds_read_b128 v[56:59], v8 offset:64
    v_mfma_f32_32x32x16_bf16 v[96:111], v[24:27], v[20:23], v[96:111]
    v_xor_b32 v6, s63, v6
    s_waitcnt lgkmcnt(3)
    v_mfma_f32_32x32x16_bf16 v[80:95], v[40:43], v[32:35], v[80:95]
    ds_read_b128 v[64:67], v7 offset:0
    ds_read_b128 v[68:71], v7 offset:4096
    ds_read_b128 v[72:75], v8 offset:96
    v_mfma_f32_32x32x16_bf16 v[96:111], v[40:43], v[36:39], v[96:111]
    v_xor_b32 v7, s63, v7
    v_add_u32 v8, s50, v9
    s_add_u32 s50, s50, 128
    s_cmp_eq_u32 s50, 1152
    s_cselect_b32 s50, 0, s50
    s_cmp_eq_u32 s62, 9
    s_waitcnt lgkmcnt(3)
    v_mfma_f32_32x32x16_bf16 v[80:95], v[56:59], v[48:51], v[80:95]
    s_cbranch_scc1 L_gt_nb
    s_barrier
    L_gt_nb:
    ds_read_b128 v[16:19], v4 offset:0
    ds_read_b128 v[20:23], v4 offset:4096
    ds_read_b128 v[24:27], v8 offset:0
    v_mfma_f32_32x32x16_bf16 v[96:111], v[56:59], v[52:55], v[96:111]
    v_xor_b32 v4, s64, v4
    s_waitcnt lgkmcnt(3)
    v_mfma_f32_32x32x16_bf16 v[80:95], v[72:75], v[64:67], v[80:95]
    ds_read_b128 v[32:35], v5 offset:0
    ds_read_b128 v[36:39], v5 offset:4096
    ds_read_b128 v[40:43], v8 offset:32
    v_mfma_f32_32x32x16_bf16 v[96:111], v[72:75], v[68:71], v[96:111]
    v_xor_b32 v5, s64, v5
    s_mov_b32 s63, s64
    s_xor_b32 s64, s64, 0x10000
    s_add_u32 s62, s62, 1
    s_cmp_lt_u32 s62, 10
    s_cbranch_scc1 L_gt_loop
    s_lshl_b32 s52, s56, 9
    s_add_u32 s52, s52, 9543680
    v_lshlrev_b32 v1, 3, v0
    s_nop 3
    s_mov_b32 exec_lo, 0
    v_mov_b32 v80, v96
    s_mov_b32 exec_lo, -1
    v_cvt_pk_bf16_f32 v80, v80, v80
    v_and_b32 v80, 0xffff0000, v80
    v_mul_f32 v80, 0xbfb8aa3b, v80
    v_exp_f32 v80, v80
    s_nop 0
    v_add_f32 v80, 1.0, v80
    v_rcp_f32 v80, v80
    s_nop 0
    v_cvt_pk_bf16_f32 v80, v80, v80
    v_and_b32 v80, 0xffff0000, v80
    v_sub_f32 v81, 1.0, v80
    v_cvt_pk_bf16_f32 v81, v81, v81
    v_and_b32 v81, 0xffff0000, v81
    buffer_store_dwordx2 v[80:81], v1, s[12:15], s52 offen sc1
    s_branch L_g_pub
L_g_vtype:
    s_mul_i32 s58, s56, 74752
    s_lshl_b32 s59, s57, 10
    s_add_u32 s58, s58, s59
    s_add_u32 s58, s58, 4700160
    s_add_u32 s59, s58, 18688
    s_add_u32 s60, s58, 37376
    s_add_u32 s61, s59, 37376
    v_mul_u32_u24 v2, 9344, v2
    v_and_b32 v1, 31, v0
    v_lshl_add_u32 v1, v1, 4, v2
.p2align 6
L_gm2:
    s_waitcnt lgkmcnt(6)
    v_mfma_f32_32x32x16_bf16 v[80:95], v[16:19], v[24:27], v[80:95]
    ds_read_b128 v[48:51], v6 offset:0
    ds_read_b128 v[52:55], v6 offset:4096
    v_mfma_f32_32x32x16_bf16 v[96:111], v[16:19], v[28:31], v[96:111]
    ds_read_b64_tr_b16 v[56:57], v8 offset:8192
    ds_read_b64_tr_b16 v[58:59], v8 offset:9216
    v_mfma_f32_32x32x16_bf16 v[112:127], v[20:23], v[24:27], v[112:127]
    ds_read_b64_tr_b16 v[60:61], v9 offset:8192
    ds_read_b64_tr_b16 v[62:63], v9 offset:9216
    v_mfma_f32_32x32x16_bf16 v[128:143], v[20:23], v[28:31], v[128:143]
    v_xor_b32 v6, s63, v6
    s_waitcnt lgkmcnt(6)
    v_mfma_f32_32x32x16_bf16 v[80:95], v[32:35], v[40:43], v[80:95]
    ds_read_b128 v[64:67], v7 offset:0
    ds_read_b128 v[68:71], v7 offset:4096
    v_mfma_f32_32x32x16_bf16 v[96:111], v[32:35], v[44:47], v[96:111]
    ds_read_b64_tr_b16 v[72:73], v8 offset:12288
    ds_read_b64_tr_b16 v[74:75], v8 offset:13312
    v_mfma_f32_32x32x16_bf16 v[112:127], v[36:39], v[40:43], v[112:127]
    ds_read_b64_tr_b16 v[76:77], v9 offset:12288
    ds_read_b64_tr_b16 v[78:79], v9 offset:13312
    s_cmp_eq_u32 s62, 9
    v_mfma_f32_32x32x16_bf16 v[128:143], v[36:39], v[44:47], v[128:143]
    v_xor_b32 v7, s63, v7
    v_xor_b32 v8, s63, v8
    v_xor_b32 v9, s63, v9
    s_waitcnt lgkmcnt(6)
    v_mfma_f32_32x32x16_bf16 v[80:95], v[48:51], v[56:59], v[80:95]
    s_cbranch_scc1 L_g_v
    s_barrier
    ds_read_b128 v[16:19], v4 offset:0
    ds_read_b128 v[20:23], v4 offset:4096
    v_mfma_f32_32x32x16_bf16 v[96:111], v[48:51], v[60:63], v[96:111]
    ds_read_b64_tr_b16 v[24:25], v8 offset:0
    ds_read_b64_tr_b16 v[26:27], v8 offset:1024
    v_mfma_f32_32x32x16_bf16 v[112:127], v[52:55], v[56:59], v[112:127]
    ds_read_b64_tr_b16 v[28:29], v9 offset:0
    ds_read_b64_tr_b16 v[30:31], v9 offset:1024
    v_mfma_f32_32x32x16_bf16 v[128:143], v[52:55], v[60:63], v[128:143]
    v_xor_b32 v4, s64, v4
    s_waitcnt lgkmcnt(6)
    v_mfma_f32_32x32x16_bf16 v[80:95], v[64:67], v[72:75], v[80:95]
    ds_read_b128 v[32:35], v5 offset:0
    ds_read_b128 v[36:39], v5 offset:4096
    v_mfma_f32_32x32x16_bf16 v[96:111], v[64:67], v[76:79], v[96:111]
    ds_read_b64_tr_b16 v[40:41], v8 offset:4096
    ds_read_b64_tr_b16 v[42:43], v8 offset:5120
    s_add_u32 s62, s62, 1
    v_mfma_f32_32x32x16_bf16 v[112:127], v[68:71], v[72:75], v[112:127]
    ds_read_b64_tr_b16 v[44:45], v9 offset:4096
    ds_read_b64_tr_b16 v[46:47], v9 offset:5120
    v_xor_b32 v5, s64, v5
    s_mov_b32 s63, s64
    s_xor_b32 s64, s64, 0x10000
    v_mfma_f32_32x32x16_bf16 v[128:143], v[68:71], v[76:79], v[128:143]
    s_branch L_gm2
    L_g_v:
    s_waitcnt lgkmcnt(0)
    v_mfma_f32_32x32x16_bf16 v[80:95], v[64:67], v[72:75], v[80:95]
    s_nop 4
    v_mfma_f32_32x32x16_bf16 v[96:111], v[48:51], v[60:63], v[96:111]
    s_nop 4
    v_mfma_f32_32x32x16_bf16 v[96:111], v[64:67], v[76:79], v[96:111]
    v_cvt_pk_bf16_f32 v80, v80, v81
    v_cvt_pk_bf16_f32 v81, v82, v83
    v_cvt_pk_bf16_f32 v82, v84, v85
    v_cvt_pk_bf16_f32 v83, v86, v87
    buffer_store_dwordx4 v[80:83], v1, s[12:15], s58 offen offset:0 sc1
    v_mfma_f32_32x32x16_bf16 v[112:127], v[52:55], v[56:59], v[112:127]
    v_cvt_pk_bf16_f32 v84, v88, v89
    v_cvt_pk_bf16_f32 v85, v90, v91
    v_cvt_pk_bf16_f32 v86, v92, v93
    v_cvt_pk_bf16_f32 v87, v94, v95
    buffer_store_dwordx4 v[84:87], v1, s[12:15], s59 offen offset:0 sc1
    v_mfma_f32_32x32x16_bf16 v[112:127], v[68:71], v[72:75], v[112:127]
    v_cvt_pk_bf16_f32 v96, v96, v97
    v_cvt_pk_bf16_f32 v97, v98, v99
    v_cvt_pk_bf16_f32 v98, v100, v101
    v_cvt_pk_bf16_f32 v99, v102, v103
    buffer_store_dwordx4 v[96:99], v1, s[12:15], s58 offen offset:512 sc1
    v_mfma_f32_32x32x16_bf16 v[128:143], v[52:55], v[60:63], v[128:143]
    v_cvt_pk_bf16_f32 v100, v104, v105
    v_cvt_pk_bf16_f32 v101, v106, v107
    v_cvt_pk_bf16_f32 v102, v108, v109
    v_cvt_pk_bf16_f32 v103, v110, v111
    buffer_store_dwordx4 v[100:103], v1, s[12:15], s59 offen offset:512 sc1
    v_mfma_f32_32x32x16_bf16 v[128:143], v[68:71], v[76:79], v[128:143]
    v_cvt_pk_bf16_f32 v112, v112, v113
    v_cvt_pk_bf16_f32 v113, v114, v115
    v_cvt_pk_bf16_f32 v114, v116, v117
    v_cvt_pk_bf16_f32 v115, v118, v119
    buffer_store_dwordx4 v[112:115], v1, s[12:15], s60 offen offset:0 sc1
    v_cvt_pk_bf16_f32 v116, v120, v121
    v_cvt_pk_bf16_f32 v117, v122, v123
    v_cvt_pk_bf16_f32 v118, v124, v125
    v_cvt_pk_bf16_f32 v119, v126, v127
    buffer_store_dwordx4 v[116:119], v1, s[12:15], s61 offen offset:0 sc1
    s_nop 1
    v_cvt_pk_bf16_f32 v128, v128, v129
    v_cvt_pk_bf16_f32 v129, v130, v131
    v_cvt_pk_bf16_f32 v130, v132, v133
    v_cvt_pk_bf16_f32 v131, v134, v135
    buffer_store_dwordx4 v[128:131], v1, s[12:15], s60 offen offset:512 sc1
    v_cvt_pk_bf16_f32 v132, v136, v137
    v_cvt_pk_bf16_f32 v133, v138, v139
    v_cvt_pk_bf16_f32 v134, v140, v141
    v_cvt_pk_bf16_f32 v135, v142, v143
    buffer_store_dwordx4 v[132:135], v1, s[12:15], s61 offen offset:512 sc1
L_g_pub:
    s_setprio 0
    s_waitcnt lgkmcnt(0)
    s_and_b32 s96, s2, 7
    s_lshl_b32 s96, s96, 2
    s_lshr_b32 s97, s2, 6
    s_add_u32 s96, s96, s97
    s_bfe_u32 s97, s2, 0x30003
    s_and_b32 s50, s3, 3
    s_lshr_b32 s51, s3, 2
    s_lshl_b32 s52, s97, 3
    s_lshl_b32 s50, s50, 1
    s_add_u32 s52, s52, s50
    s_add_u32 s53, s52, s51
    s_lshr_b32 s55, s96, 1
    s_mul_i32 s55, s55, 2304
    s_and_b32 s56, s96, 1
    s_mul_i32 s57, s56, 1280
    s_add_u32 s57, s57, s55
    s_add_u32 s55, s55, 1024
    v_and_b32 v36, 15, v0
    v_lshlrev_b32 v36, 4, v36
    v_bfe_u32 v37, v0, 4, 1
    v_lshl_or_b32 v36, v37, 3, v36
    v_lshrrev_b32 v33, 5, v0
    v_lshl_or_b32 v37, v33, 8, v36
    v_and_b32 v38, 31, v0
    v_lshlrev_b32 v39, 3, v38
    s_lshl_b32 s62, s52, 8
    s_add_u32 s62, s62, 9543680
    s_lshl_b32 s59, s50, 11
    s_add_u32 s54, s59, 81920
    v_add_u32 v35, s54, v37
    s_lshl_b32 s60, s51, 8
    v_xor_b32 v34, s60, v35
    v_and_b32 v29, 0x13f, v37
    v_bfe_u32 v32, v0, 2, 1
    v_lshl_or_b32 v29, v32, 7, v29
    v_bfe_u32 v32, v0, 3, 1
    v_lshl_or_b32 v29, v32, 6, v29
    s_mul_i32 s59, s51, 10240
    v_add_u32 v29, s59, v29
    v_mad_u32_u24 v32, v33, 20, v38
    s_add_u32 s59, s59, 5120
    v_lshl_add_u32 v30, v32, 4, s59
    s_mul_i32 s59, s53, 36864
    s_add_u32 s59, s59, 9560064
    s_lshl_b32 s100, s96, 10
    s_add_u32 s100, s100, s59
    s_lshl_b32 s101, s96, 7
    s_add_u32 s101, s101, s59
    s_add_u32 s101, s101, 32768
    s_mov_b32 vcc_lo, 0x7ffff
    s_mov_b32 vcc_hi, 0x7ffff
    v_mov_b32 v28, 0x80000
    v_cndmask_b32 v30, v28, v30, vcc
    v_mov_b32 v28, 0xdddddddd
    v_mov_b32 v62, 0
    v_mov_b32 v63, 0
    v_mov_b32 v64, 0
    v_mov_b32 v65, 0
    v_mov_b32 v66, 0
    v_mov_b32 v67, 0
    v_mov_b32 v68, 0
    v_mov_b32 v69, 0
    v_mov_b32 v70, 0
    v_mov_b32 v71, 0
    v_mov_b32 v72, 0
    v_mov_b32 v73, 0
    v_mov_b32 v74, 0
    v_mov_b32 v75, 0
    v_mov_b32 v76, 0
    v_mov_b32 v77, 0
    v_mov_b32 v78, 0
    v_mov_b32 v79, 0
    v_mov_b32 v80, 0
    v_mov_b32 v81, 0
    v_mov_b32 v82, 0
    v_mov_b32 v83, 0
    v_mov_b32 v84, 0
    v_mov_b32 v85, 0
    v_mov_b32 v86, 0
    v_mov_b32 v87, 0
    v_mov_b32 v88, 0
    v_mov_b32 v89, 0
    v_mov_b32 v90, 0
    v_mov_b32 v91, 0
    v_mov_b32 v92, 0
    v_mov_b32 v93, 0
    s_setprio 2
    s_mov_b32 exec_hi, 0
    s_waitcnt vmcnt(0)
    buffer_store_dword v12, v13, s[12:15], s65 offen sc1
    s_mov_b64 exec, 1
    ds_add_u32 v10, v11 offset:0
    s_mov_b64 exec, -1
    s_waitcnt lgkmcnt(0)
    s_branch L_attn2
L_gate:
    s_setprio 3
    s_and_b32 s51, s3, 3
    s_getpc_b64 s[54:55]
    L_pf_pc:
    s_sub_u32 s54, s54, L_pf_pc-gated_mix__ssm_conv_s4__mha_block__prompt_kernel
    s_subb_u32 s55, s55, 0
    s_bfe_u32 s52, s2, 0x20003
    s_lshl2_add_u32 s52, s52, s51
    s_mul_i32 s52, s52, 2560
    v_lshl_add_u32 v1, v0, 7, s52
    s_mov_b64 exec, 0xfffff
    global_load_dword v61, v1, s[54:55]
    s_mov_b64 exec, -1
    v_mul_u32_u24 v1, 2304, v0
    s_mul_i32 s52, s51, 589824
    s_lshl_b32 s53, s99, 1
    s_add_u32 s52, s52, s53
    s_waitcnt lgkmcnt(0)
    s_mov_b32 s4, s16
    s_mov_b32 s5, s17
    s_mov_b32 s6, 2359296
    s_mov_b32 s7, 0x00020000
    s_barrier
    buffer_load_dwordx2 v[16:17], v1, s[4:7], s52 offen offset:0
    buffer_load_dwordx2 v[18:19], v1, s[4:7], s52 offen offset:1152
    s_add_u32 s52, s52, 147456
    buffer_load_dwordx2 v[20:21], v1, s[4:7], s52 offen offset:0
    buffer_load_dwordx2 v[22:23], v1, s[4:7], s52 offen offset:1152
    s_add_u32 s52, s52, 147456
    buffer_load_dwordx2 v[24:25], v1, s[4:7], s52 offen offset:0
    buffer_load_dwordx2 v[26:27], v1, s[4:7], s52 offen offset:1152
    s_add_u32 s52, s52, 147456
    buffer_load_dwordx2 v[28:29], v1, s[4:7], s52 offen offset:0
    buffer_load_dwordx2 v[30:31], v1, s[4:7], s52 offen offset:1152
    s_mov_b32 s12, s46
    s_mov_b32 s13, s47
    s_mov_b32 s14, 17766528
    s_mov_b32 s15, 0x00020000
    s_add_u32 s100, s46, 17651712
    s_addc_u32 s101, s47, 0
    s_load_dword s70, s[100:101], 0
    s_sub_u32 s53, s2, 224
    s_lshl2_add_u32 s53, s53, s51
    s_mul_i32 s53, s53, 4096
    s_add_u32 s53, s53, 17301504
    v_and_b32 v10, 31, v0
    v_mul_u32_u24 v10, 128, v10
    buffer_load_dword v60, v10, s[12:15], s53 offen
    v_lshlrev_b32 v10, 2, v0
    s_lshl_b32 s53, s51, 10
    v_add_u32 v2, s53, v10
    v_mov_b32 v9, 0
    v_mov_b32 v8, 157696
    v_mov_b32 v3, 1
    s_mov_b32 s54, 0x05040100
    s_mov_b32 s55, 0x07060302
    s_waitcnt lgkmcnt(0)
    s_mul_i32 s70, s70, 0x9e3779b1
    s_add_u32 s70, s70, 0x7f4a7c15
    s_waitcnt vmcnt(7)
    v_perm_b32 v40, v19, v17, s54
    v_perm_b32 v44, v19, v17, s55
    v_perm_b32 v32, v18, v16, s54
    v_perm_b32 v36, v18, v16, s55
    s_waitcnt vmcnt(5)
    v_perm_b32 v41, v23, v21, s54
    v_perm_b32 v45, v23, v21, s55
    v_perm_b32 v33, v22, v20, s54
    v_perm_b32 v37, v22, v20, s55
    s_waitcnt vmcnt(3)
    v_perm_b32 v42, v27, v25, s54
    v_perm_b32 v46, v27, v25, s55
    v_perm_b32 v34, v26, v24, s54
    v_perm_b32 v38, v26, v24, s55
    s_waitcnt vmcnt(1)
    v_perm_b32 v43, v31, v29, s54
    v_perm_b32 v47, v31, v29, s55
    v_perm_b32 v35, v30, v28, s54
    v_perm_b32 v39, v30, v28, s55
    s_cmp_lg_u32 s51, 0
    s_cbranch_scc1 L_ug3
    v_add_u32 v11, 0, v10
    s_mov_b64 exec, 0x7fffffff
    ds_write_b32 v11, v9 offset:0
    ds_write_b32 v11, v9 offset:4288
    ds_write_b32 v11, v9 offset:8576
    ds_write_b32 v11, v9 offset:12864
    ds_write_b32 v11, v9 offset:17152
    ds_write_b32 v11, v9 offset:21440
    ds_write_b32 v11, v9 offset:25728
    ds_write_b32 v11, v9 offset:30016
    s_mov_b64 exec, -1
    L_ug3:
    v_add_u32 v11, 124, v2
    ds_write2st64_b32 v11, v40, v41 offset0:0 offset1:1
    ds_write2st64_b32 v11, v42, v43 offset0:2 offset1:3
    v_add_u32 v12, 4408, v2
    ds_write2st64_b32 v12, v40, v41 offset0:0 offset1:1
    ds_write2st64_b32 v12, v42, v43 offset0:2 offset1:3
    v_add_u32 v11, 8692, v2
    ds_write2st64_b32 v11, v40, v41 offset0:0 offset1:1
    ds_write2st64_b32 v11, v42, v43 offset0:2 offset1:3
    v_add_u32 v12, 12976, v2
    ds_write2st64_b32 v12, v40, v41 offset0:0 offset1:1
    ds_write2st64_b32 v12, v42, v43 offset0:2 offset1:3
    v_add_u32 v11, 17276, v2
    ds_write2st64_b32 v11, v44, v45 offset0:0 offset1:1
    ds_write2st64_b32 v11, v46, v47 offset0:2 offset1:3
    v_add_u32 v12, 21560, v2
    ds_write2st64_b32 v12, v44, v45 offset0:0 offset1:1
    ds_write2st64_b32 v12, v46, v47 offset0:2 offset1:3
    v_add_u32 v11, 25844, v2
    ds_write2st64_b32 v11, v44, v45 offset0:0 offset1:1
    ds_write2st64_b32 v11, v46, v47 offset0:2 offset1:3
    v_add_u32 v12, 30128, v2
    ds_write2st64_b32 v12, v44, v45 offset0:0 offset1:1
    ds_write2st64_b32 v12, v46, v47 offset0:2 offset1:3
    s_mov_b64 exec, 1
    ds_add_u32 v8, v3 offset:24
    ds_add_u32 v8, v3 offset:28
    s_mov_b64 exec, -1
    s_mov_b32 s71, 0x100000
    L_lp4:
    ds_read_b128 v[4:7], v8 offset:48
    s_sub_u32 s71, s71, 1
    s_cbranch_scc1 L_le5
    s_waitcnt lgkmcnt(0)
    v_min3_u32 v4, v4, v5, v6
    v_min_u32 v4, v4, v7
    s_nop 0
    v_readfirstlane_b32 s69, v4
    s_cmp_ge_u32 s69, 1
    s_cbranch_scc1 L_le5
    s_sleep 1
    s_branch L_lp4
    L_le5:
    s_cmp_lg_u32 s51, 0
    s_cbranch_scc1 L_ug6
    v_add_u32 v11, 98304, v10
    s_mov_b64 exec, 0x7fffffff
    ds_write_b32 v11, v9 offset:0
    ds_write_b32 v11, v9 offset:4288
    ds_write_b32 v11, v9 offset:8576
    ds_write_b32 v11, v9 offset:12864
    ds_write_b32 v11, v9 offset:17152
    ds_write_b32 v11, v9 offset:21440
    ds_write_b32 v11, v9 offset:25728
    ds_write_b32 v11, v9 offset:30016
    s_mov_b64 exec, -1
    L_ug6:
    v_add_u32 v11, 98428, v2
    ds_write2st64_b32 v11, v32, v33 offset0:0 offset1:1
    ds_write2st64_b32 v11, v34, v35 offset0:2 offset1:3
    v_add_u32 v12, 102712, v2
    ds_write2st64_b32 v12, v32, v33 offset0:0 offset1:1
    ds_write2st64_b32 v12, v34, v35 offset0:2 offset1:3
    v_add_u32 v11, 106996, v2
    ds_write2st64_b32 v11, v32, v33 offset0:0 offset1:1
    ds_write2st64_b32 v11, v34, v35 offset0:2 offset1:3
    v_add_u32 v12, 111280, v2
    ds_write2st64_b32 v12, v32, v33 offset0:0 offset1:1
    ds_write2st64_b32 v12, v34, v35 offset0:2 offset1:3
    v_add_u32 v11, 115580, v2
    ds_write2st64_b32 v11, v36, v37 offset0:0 offset1:1
    ds_write2st64_b32 v11, v38, v39 offset0:2 offset1:3
    v_add_u32 v12, 119864, v2
    ds_write2st64_b32 v12, v36, v37 offset0:0 offset1:1
    ds_write2st64_b32 v12, v38, v39 offset0:2 offset1:3
    v_add_u32 v11, 124148, v2
    ds_write2st64_b32 v11, v36, v37 offset0:0 offset1:1
    ds_write2st64_b32 v11, v38, v39 offset0:2 offset1:3
    v_add_u32 v12, 128432, v2
    ds_write2st64_b32 v12, v36, v37 offset0:0 offset1:1
    ds_write2st64_b32 v12, v38, v39 offset0:2 offset1:3
    s_mov_b64 exec, 1
    ds_add_u32 v8, v3 offset:16
    ds_add_u32 v8, v3 offset:20
    s_mov_b64 exec, -1
    s_branch L_kv
L_aux:
    s_cmp_ge_u32 s2, 256
    s_cbranch_scc1 L_exit
    s_cmp_lg_u32 s3, 9
    s_cbranch_scc1 L_aux1
    v_mov_b32 v2, 0
    v_lshlrev_b32 v3, 2, v0
    v_add_u32 v3, 157696, v3
    ds_write_b32 v3, v2
    L_aux1:
    s_and_b32 s50, s2, 7
    s_bfe_u32 s99, s2, 0x20003
    s_lshl2_add_u32 s99, s50, s99
    s_lshl2_add_u32 s99, s99, 448
    s_mov_b32 s98, 0
    s_cmp_ge_u32 s3, 8
    s_cbranch_scc1 L_gate
    s_cmp_ge_u32 s3, 4
    s_cbranch_scc1 L_kgl
    s_mov_b32 s98, 98304
    s_add_u32 s99, s99, 2
    s_branch L_kgl
    L_kgen:
    s_add_u32 s99, s99, s50
    s_bfe_u32 s63, s3, 0x10001
    s_cmp_lg_u32 s98, 0
    s_cselect_b32 s51, 32768, 0
    s_cselect_b32 s53, 16, 0
    s_add_u32 s51, s51, 65536
    s_add_u32 s53, s53, 157696
    s_and_b32 s52, s3, 3
    s_mul_i32 s49, s52, 8160
    s_add_u32 s49, s49, s51
    s_xor_b32 s52, s52, 2
    s_mul_i32 s64, s52, 8160
    s_add_u32 s64, s64, s51
    s_mul_i32 s67, s50, 12416
    s_add_u32 s67, s67, 132608
    s_sub_u32 s67, s67, s98
    s_lshl_b32 s50, s50, 3
    s_lshl_b32 s51, s63, 2
    s_add_u32 s50, s50, s51
    s_add_u32 s50, s50, s53
    v_mov_b32 v3, s50
    s_cmp_lt_u32 s2, 224
    s_cbranch_scc1 L_kg_nb
    s_barrier
    L_kg_nb:
    s_mov_b32 s12, s46
    s_mov_b32 s13, s47
    s_mov_b32 s14, 17766528
    s_mov_b32 s15, 0x00020000
    s_add_u32 s100, s46, 17651712
    s_addc_u32 s101, s47, 0
    s_load_dword s70, s[100:101], 0
    v_mov_b32 v22, 0x3fb8aa3b
    v_mov_b32 v23, 0x3e22f983
    v_mov_b32 v24, 0x43b2e4e9
    v_mov_b32 v25, 0x421de1b7
    s_mov_b32 exec_lo, 0
    v_mov_b32 v22, 0x4138aa3b
    v_mov_b32 v23, 0xbfa2f983
    v_mov_b32 v24, v22
    v_mov_b32 v25, v23
    s_mov_b32 exec_lo, -1
    s_sub_u32 m0, s49, 57344
    v_lshrrev_b32 v27, 5, v0
    v_mul_u32_u24 v58, 1552, v27
    v_lshl_add_u32 v1, v1, 4, v58
    v_add_u32 v1, s67, v1
    v_lshl_add_u32 v2, v0, 4, s49
    v_lshl_add_u32 v11, v0, 4, s64
    v_xor_b32 v26, 4, v3
    s_and_b32 s50, s3, 1
    s_bfe_u32 s51, s3, 0x10001
    s_mul_i32 s52, s50, 17152
    s_add_u32 s52, s52, 98304
    s_sub_u32 s52, s52, s98
    s_lshl_b32 s53, s51, 9
    s_add_u32 s52, s52, s53
    s_mul_i32 s53, s50, 12416
    s_add_u32 s53, s53, 133056
    s_sub_u32 s53, s53, s98
    s_lshl_b32 s54, s51, 7
    s_sub_u32 s53, s53, s54
    v_and_b32 v132, 3, v0
    v_mul_u32_u24 v132, 4288, v132
    v_lshrrev_b32 v134, 4, v0
    v_bfe_u32 v133, v0, 3, 1
    v_add_u32 v131, v133, v134
    v_bfe_u32 v133, v0, 2, 1
    v_lshl_add_u32 v131, v133, 1, v131
    v_lshl_add_u32 v131, v131, 4, v132
    v_add_u32 v131, s52, v131
    v_mul_u32_u24 v134, 1552, v134
    v_and_b32 v133, 15, v0
    v_lshl_add_u32 v135, v133, 4, v134
    s_sub_u32 s54, s53, 32
    v_add_u32 v135, s54, v135
    v_bfe_u32 v133, v0, 2, 3
    v_lshrrev_b32 v134, 5, v0
    v_add_u32 v133, v133, v134
    v_lshl_add_u32 v126, v133, 4, v132
    v_add_u32 v126, s52, v126
    v_mul_u32_u24 v133, 1552, v134
    v_and_b32 v132, 31, v0
    v_lshl_add_u32 v127, v132, 4, v133
    v_add_u32 v127, s53, v127
    s_cmp_lg_u32 s98, 0
    s_cselect_b32 s56, 8, 0
    s_lshl_b32 s57, s50, 2
    s_add_u32 s56, s56, s57
    s_add_u32 s57, s56, 157696
    v_mov_b32 v128, s57
    s_add_u32 s57, s57, s56
    v_mov_b32 v129, s57
    v_lshlrev_b32 v132, 5, v132
    v_lshl_add_u32 v130, v134, 4, v132
    s_lshl_b32 s52, s99, 13
    s_lshl_b32 s53, s51, 12
    s_add_u32 s52, s52, s53
    s_add_u32 s98, s52, 11919360
    v_mov_b32 v136, 0
    v_mov_b32 v137, 0
    v_mov_b32 v138, 0
    v_mov_b32 v139, 0
    v_mov_b32 v140, 0
    v_mov_b32 v141, 0
    v_mov_b32 v142, 0
    v_mov_b32 v143, 0
    v_mov_b32 v144, 0
    v_mov_b32 v145, 0
    v_mov_b32 v146, 0
    v_mov_b32 v147, 0
    v_mov_b32 v148, 0
    v_mov_b32 v149, 0
    v_mov_b32 v150, 0
    v_mov_b32 v151, 0
    v_mov_b32 v152, 0
    v_mov_b32 v153, 0
    v_mov_b32 v154, 0
    v_mov_b32 v155, 0
    v_mov_b32 v156, 0
    v_mov_b32 v157, 0
    v_mov_b32 v158, 0
    v_mov_b32 v159, 0
    v_mov_b32 v160, 0
    v_mov_b32 v161, 0
    v_mov_b32 v162, 0
    v_mov_b32 v163, 0
    v_mov_b32 v164, 0
    v_mov_b32 v165, 0
    v_mov_b32 v166, 0
    v_mov_b32 v167, 0
    s_and_b32 s96, s2, 7
    s_lshl_b32 s96, s96, 2
    s_lshr_b32 s97, s2, 6
    s_add_u32 s96, s96, s97
    s_bfe_u32 s97, s2, 0x30003
    s_and_b32 s50, s3, 3
    s_lshr_b32 s51, s3, 2
    s_lshl_b32 s52, s97, 3
    s_lshl_b32 s50, s50, 1
    s_add_u32 s52, s52, s50
    s_add_u32 s53, s52, s51
    s_lshr_b32 s55, s96, 1
    s_mul_i32 s55, s55, 2304
    s_and_b32 s56, s96, 1
    s_mul_i32 s57, s56, 1280
    s_add_u32 s57, s57, s55
    s_add_u32 s55, s55, 1024
    v_and_b32 v36, 15, v0
    v_lshlrev_b32 v36, 4, v36
    v_bfe_u32 v37, v0, 4, 1
    v_lshl_or_b32 v36, v37, 3, v36
    v_lshrrev_b32 v33, 5, v0
    v_lshl_or_b32 v37, v33, 8, v36
    v_and_b32 v38, 31, v0
    v_lshlrev_b32 v39, 3, v38
    s_lshl_b32 s62, s52, 8
    s_add_u32 s62, s62, 9543680
    s_lshl_b32 s59, s50, 11
    s_add_u32 s54, s59, 81920
    v_add_u32 v35, s54, v37
    s_lshl_b32 s60, s51, 8
    v_xor_b32 v34, s60, v35
    v_and_b32 v29, 0x13f, v37
    v_bfe_u32 v32, v0, 2, 1
    v_lshl_or_b32 v29, v32, 7, v29
    v_bfe_u32 v32, v0, 3, 1
    v_lshl_or_b32 v29, v32, 6, v29
    s_mul_i32 s59, s51, 10240
    v_add_u32 v29, s59, v29
    v_mad_u32_u24 v32, v33, 20, v38
    s_add_u32 s59, s59, 5120
    v_lshl_add_u32 v30, v32, 4, s59
    s_mul_i32 s59, s53, 36864
    s_add_u32 s59, s59, 9560064
    s_lshl_b32 s100, s96, 10
    s_add_u32 s100, s100, s59
    s_lshl_b32 s101, s96, 7
    s_add_u32 s101, s101, s59
    s_add_u32 s101, s101, 32768
    s_mov_b32 vcc_lo, 0x7ffff
    s_mov_b32 vcc_hi, 0x7ffff
    v_mov_b32 v28, 0x80000
    v_cndmask_b32 v30, v28, v30, vcc
    v_mov_b32 v28, 0xdddddddd
    s_waitcnt lgkmcnt(0)
    s_mul_i32 s70, s70, 0x9e3779b1
    s_add_u32 s70, s70, 0x7f4a7c15
    s_mov_b32 vcc_lo, 0xf0f0f0f0
    s_mov_b32 vcc_hi, 0xf0f0f0f0
    s_and_b32 s48, s3, 1
    s_lshl_b32 s48, s48, 4
    s_lshr_b32 s65, s65, s48
    s_lshl_b32 s65, s65, 16
    s_lshr_b32 s66, s66, s48
    s_lshl_b32 s66, s66, 16
    v_mov_b32 v20, 0x3fb8aa3b
    v_mul_f32 v20, s65, v20
    v_exp_f32 v20, v20
    v_mov_b32 v21, s66
    v_cvt_pk_bf16_f32 v20, v20, v20
    v_and_b32 v20, 0xffff0000, v20
    s_cmp_ge_u32 s2, 224
    s_cbranch_scc1 L_gb7
    s_barrier
    L_gb7:
    s_waitcnt vmcnt(0)
    v_lshlrev_b32 v52, 16, v4
    v_lshlrev_b32 v53, 16, v5
    v_lshlrev_b32 v54, 16, v6
    v_lshlrev_b32 v55, 16, v7
    v_lshlrev_b32 v56, 16, v8
    v_lshlrev_b32 v57, 16, v9
    v_mul_f32 v52, v20, v52
    v_mul_f32 v53, v20, v53
    v_mul_f32 v12, v22, v52
    v_mul_f32 v13, v23, v53
    v_mul_f32 v14, v24, v52
    v_mul_f32 v15, v25, v53
    v_fract_f32 v13, v13
    v_fract_f32 v15, v15
    v_exp_f32 v12, v12
    v_cos_f32 v40, v13
    v_sin_f32 v41, v13
    v_exp_f32 v14, v14
    v_cos_f32 v48, v15
    v_sin_f32 v49, v15
    v_mul_f32 v54, v20, v54
    v_mul_f32 v55, v20, v55
    v_mul_f32 v50, v55, v57
    v_mul_f32 v51, v55, v56
    v_fmac_f32 v51, v54, v57
    v_fma_f32 v50, v54, v56, -v50
    v_mul_f32 v40, v12, v40
    v_mul_f32 v41, v12, v41
    v_mul_f32 v48, v14, v48
    v_mul_f32 v49, v14, v49
    v_mul_f32 v42, v41, v41
    v_add_f32 v43, v40, v40
    v_mul_f32 v43, v43, v41
    v_fma_f32 v42, v40, v40, -v42
    v_mul_f32 v44, v43, v43
    v_add_f32 v45, v42, v42
    v_mul_f32 v45, v45, v43
    v_fma_f32 v44, v42, v42, -v44
    v_mul_f32 v46, v45, v45
    v_add_f32 v47, v44, v44
    v_mul_f32 v47, v47, v45
    v_fma_f32 v46, v44, v44, -v46
    s_mov_b32 exec_lo, 0
    v_mov_b32 v42, v40
    v_mov_b32 v43, v41
    v_mov_b32 v44, v40
    v_mov_b32 v45, v41
    v_mov_b32 v46, v40
    v_mov_b32 v47, v41
    v_mov_b32 v50, 1.0
    v_mov_b32 v51, 0
    s_mov_b32 exec_lo, -1
    v_cvt_pk_bf16_f32 v62, v50, v51
    v_mul_f32 v12, v51, v41
    v_mul_f32 v51, v51, v40
    v_fmac_f32 v51, v50, v41
    s_cmp_ge_u32 s2, 224
    s_cbranch_scc1 L_gb8
    s_barrier
    L_gb8:
    v_fma_f32 v50, v50, v40, -v12
    v_cvt_pk_bf16_f32 v63, v50, v51
    v_mul_f32 v12, v51, v41
    v_mul_f32 v51, v51, v40
    v_fmac_f32 v51, v50, v41
    v_fma_f32 v50, v50, v40, -v12
    v_cvt_pk_bf16_f32 v64, v50, v51
    v_mul_f32 v12, v51, v41
    v_mul_f32 v51, v51, v40
    v_fmac_f32 v51, v50, v41
    v_fma_f32 v50, v50, v40, -v12
    v_cvt_pk_bf16_f32 v65, v50, v51
    v_mul_f32 v12, v51, v41
    v_mul_f32 v51, v51, v40
    v_fmac_f32 v51, v50, v41
    v_fma_f32 v50, v50, v40, -v12
    v_cvt_pk_bf16_f32 v66, v50, v51
    v_mul_f32 v12, v51, v41
    v_mul_f32 v51, v51, v40
    v_fmac_f32 v51, v50, v41
    v_fma_f32 v50, v50, v40, -v12
    v_cvt_pk_bf16_f32 v67, v50, v51
    v_mul_f32 v12, v51, v41
    v_mul_f32 v51, v51, v40
    v_fmac_f32 v51, v50, v41
    v_fma_f32 v50, v50, v40, -v12
    v_cvt_pk_bf16_f32 v68, v50, v51
    v_mul_f32 v12, v51, v41
    v_mul_f32 v51, v51, v40
    v_fmac_f32 v51, v50, v41
    v_fma_f32 v50, v50, v40, -v12
    v_cvt_pk_bf16_f32 v69, v50, v51
    v_mul_f32 v12, v51, v41
    v_mul_f32 v51, v51, v40
    v_fmac_f32 v51, v50, v41
    v_fma_f32 v50, v50, v40, -v12
    v_cvt_pk_bf16_f32 v70, v50, v51
    v_mul_f32 v12, v51, v49
    v_mul_f32 v51, v51, v48
    v_fmac_f32 v51, v50, v49
    v_fma_f32 v50, v50, v48, -v12
    v_cvt_pk_bf16_f32 v71, v50, v51
    v_mul_f32 v12, v51, v43
    v_mul_f32 v51, v51, v42
    v_fmac_f32 v51, v50, v43
    v_fma_f32 v50, v50, v42, -v12
    v_cvt_pk_bf16_f32 v72, v50, v51
    v_mul_f32 v12, v51, v43
    v_mul_f32 v51, v51, v42
    v_fmac_f32 v51, v50, v43
    v_fma_f32 v50, v50, v42, -v12
    v_cvt_pk_bf16_f32 v73, v50, v51
    v_mul_f32 v12, v51, v43
    v_mul_f32 v51, v51, v42
    v_fmac_f32 v51, v50, v43
    v_fma_f32 v50, v50, v42, -v12
    v_cvt_pk_bf16_f32 v74, v50, v51
    v_mul_f32 v12, v51, v43
    v_mul_f32 v51, v51, v42
    v_fmac_f32 v51, v50, v43
    v_fma_f32 v50, v50, v42, -v12
    s_cmp_ge_u32 s2, 224
    s_cbranch_scc1 L_gb9
    s_barrier
    L_gb9:
    v_cvt_pk_bf16_f32 v75, v50, v51
    v_mul_f32 v12, v51, v49
    v_mul_f32 v51, v51, v48
    v_fmac_f32 v51, v50, v49
    v_fma_f32 v50, v50, v48, -v12
    v_cvt_pk_bf16_f32 v76, v50, v51
    v_mul_f32 v12, v51, v45
    v_mul_f32 v51, v51, v44
    v_fmac_f32 v51, v50, v45
    v_fma_f32 v50, v50, v44, -v12
    v_cvt_pk_bf16_f32 v77, v50, v51
    v_mul_f32 v12, v51, v45
    v_mul_f32 v51, v51, v44
    v_fmac_f32 v51, v50, v45
    v_fma_f32 v50, v50, v44, -v12
    v_cvt_pk_bf16_f32 v78, v50, v51
    v_mul_f32 v12, v51, v49
    v_mul_f32 v51, v51, v48
    v_fmac_f32 v51, v50, v49
    v_fma_f32 v50, v50, v48, -v12
    v_cvt_pk_bf16_f32 v79, v50, v51
    v_mul_f32 v12, v51, v45
    v_mul_f32 v51, v51, v44
    v_fmac_f32 v51, v50, v45
    v_fma_f32 v50, v50, v44, -v12
    v_cvt_pk_bf16_f32 v80, v50, v51
    v_mul_f32 v12, v51, v45
    v_mul_f32 v51, v51, v44
    v_fmac_f32 v51, v50, v45
    v_fma_f32 v50, v50, v44, -v12
    v_cvt_pk_bf16_f32 v81, v50, v51
    v_mul_f32 v12, v51, v49
    v_mul_f32 v51, v51, v48
    v_fmac_f32 v51, v50, v49
    v_fma_f32 v50, v50, v48, -v12
    v_cvt_pk_bf16_f32 v82, v50, v51
    v_mul_f32 v12, v51, v47
    v_mul_f32 v51, v51, v46
    v_fmac_f32 v51, v50, v47
    v_fma_f32 v50, v50, v46, -v12
    v_cvt_pk_bf16_f32 v83, v50, v51
    v_mul_f32 v12, v51, v49
    v_mul_f32 v51, v51, v48
    v_fmac_f32 v51, v50, v49
    v_fma_f32 v50, v50, v48, -v12
    v_cvt_pk_bf16_f32 v84, v50, v51
    v_mul_f32 v12, v51, v47
    v_mul_f32 v51, v51, v46
    v_fmac_f32 v51, v50, v47
    v_fma_f32 v50, v50, v46, -v12
    v_cvt_pk_bf16_f32 v85, v50, v51
    v_mul_f32 v12, v51, v49
    v_mul_f32 v51, v51, v48
    v_fmac_f32 v51, v50, v49
    v_fma_f32 v50, v50, v48, -v12
    v_cvt_pk_bf16_f32 v86, v50, v51
    v_mul_f32 v12, v51, v47
    v_mul_f32 v51, v51, v46
    v_fmac_f32 v51, v50, v47
    v_fma_f32 v50, v50, v46, -v12
    v_cvt_pk_bf16_f32 v87, v50, v51
    s_cmp_ge_u32 s2, 224
    s_cbranch_scc1 L_gb10
    s_barrier
    L_gb10:
    v_mul_f32 v12, v51, v49
    v_mul_f32 v51, v51, v48
    v_fmac_f32 v51, v50, v49
    v_fma_f32 v50, v50, v48, -v12
    v_cvt_pk_bf16_f32 v88, v50, v51
    v_mul_f32 v12, v51, v47
    v_mul_f32 v51, v51, v46
    v_fmac_f32 v51, v50, v47
    v_fma_f32 v50, v50, v46, -v12
    v_cvt_pk_bf16_f32 v89, v50, v51
    v_mul_f32 v12, v51, v47
    v_mul_f32 v51, v51, v46
    v_fmac_f32 v51, v50, v47
    v_fma_f32 v50, v50, v46, -v12
    v_cvt_pk_bf16_f32 v90, v50, v51
    v_mul_f32 v12, v51, v47
    v_mul_f32 v51, v51, v46
    v_fmac_f32 v51, v50, v47
    v_fma_f32 v50, v50, v46, -v12
    v_cvt_pk_bf16_f32 v91, v50, v51
    v_mul_f32 v12, v51, v47
    v_mul_f32 v51, v51, v46
    v_fmac_f32 v51, v50, v47
    v_fma_f32 v50, v50, v46, -v12
    v_cvt_pk_bf16_f32 v92, v50, v51
    v_mul_f32 v12, v51, v47
    v_mul_f32 v51, v51, v46
    v_fmac_f32 v51, v50, v47
    v_fma_f32 v50, v50, v46, -v12
    v_cvt_pk_bf16_f32 v93, v50, v51
    v_and_b32 v52, 0xffff0000, v4
    v_and_b32 v53, 0xffff0000, v5
    v_and_b32 v54, 0xffff0000, v6
    v_and_b32 v55, 0xffff0000, v7
    v_and_b32 v56, 0xffff0000, v8
    v_and_b32 v57, 0xffff0000, v9
    v_mul_f32 v52, v20, v52
    v_mul_f32 v53, v20, v53
    v_mul_f32 v12, v22, v52
    v_mul_f32 v13, v23, v53
    v_mul_f32 v14, v24, v52
    v_mul_f32 v15, v25, v53
    v_fract_f32 v13, v13
    v_fract_f32 v15, v15
    v_exp_f32 v12, v12
    v_cos_f32 v40, v13
    v_sin_f32 v41, v13
    v_exp_f32 v14, v14
    v_cos_f32 v48, v15
    v_sin_f32 v49, v15
    v_mul_f32 v54, v20, v54
    v_mul_f32 v55, v20, v55
    v_mul_f32 v50, v55, v57
    v_mul_f32 v51, v55, v56
    v_fmac_f32 v51, v54, v57
    s_cmp_ge_u32 s2, 224
    s_cbranch_scc1 L_gb11
    s_barrier
    L_gb11:
    v_fma_f32 v50, v54, v56, -v50
    v_mul_f32 v40, v12, v40
    v_mul_f32 v41, v12, v41
    v_mul_f32 v48, v14, v48
    v_mul_f32 v49, v14, v49
    v_mul_f32 v42, v41, v41
    v_add_f32 v43, v40, v40
    v_mul_f32 v43, v43, v41
    v_fma_f32 v42, v40, v40, -v42
    v_mul_f32 v44, v43, v43
    v_add_f32 v45, v42, v42
    v_mul_f32 v45, v45, v43
    v_fma_f32 v44, v42, v42, -v44
    v_mul_f32 v46, v45, v45
    v_add_f32 v47, v44, v44
    v_mul_f32 v47, v47, v45
    v_fma_f32 v46, v44, v44, -v46
    s_mov_b32 exec_lo, 0
    v_mov_b32 v42, v40
    v_mov_b32 v43, v41
    v_mov_b32 v44, v40
    v_mov_b32 v45, v41
    v_mov_b32 v46, v40
    v_mov_b32 v47, v41
    v_mov_b32 v50, 1.0
    v_mov_b32 v51, 0
    s_mov_b32 exec_lo, -1
    v_cvt_pk_bf16_f32 v94, v50, v51
    v_mul_f32 v12, v51, v41
    v_mul_f32 v51, v51, v40
    v_fmac_f32 v51, v50, v41
    v_fma_f32 v50, v50, v40, -v12
    v_cvt_pk_bf16_f32 v95, v50, v51
    v_mul_f32 v12, v51, v41
    v_mul_f32 v51, v51, v40
    v_fmac_f32 v51, v50, v41
    v_fma_f32 v50, v50, v40, -v12
    v_cvt_pk_bf16_f32 v96, v50, v51
    v_mul_f32 v12, v51, v41
    v_mul_f32 v51, v51, v40
    v_fmac_f32 v51, v50, v41
    v_fma_f32 v50, v50, v40, -v12
    v_cvt_pk_bf16_f32 v97, v50, v51
    v_mul_f32 v12, v51, v41
    v_mul_f32 v51, v51, v40
    v_fmac_f32 v51, v50, v41
    v_fma_f32 v50, v50, v40, -v12
    v_cvt_pk_bf16_f32 v98, v50, v51
    v_mul_f32 v12, v51, v41
    v_mul_f32 v51, v51, v40
    v_fmac_f32 v51, v50, v41
    v_fma_f32 v50, v50, v40, -v12
    v_cvt_pk_bf16_f32 v99, v50, v51
    v_mul_f32 v12, v51, v41
    v_mul_f32 v51, v51, v40
    v_fmac_f32 v51, v50, v41
    v_fma_f32 v50, v50, v40, -v12
    v_cvt_pk_bf16_f32 v100, v50, v51
    v_mul_f32 v12, v51, v41
    v_mul_f32 v51, v51, v40
    v_fmac_f32 v51, v50, v41
    s_cmp_ge_u32 s2, 224
    s_cbranch_scc1 L_gb12
    s_barrier
    L_gb12:
    v_fma_f32 v50, v50, v40, -v12
    v_cvt_pk_bf16_f32 v101, v50, v51
    v_mul_f32 v12, v51, v41
    v_mul_f32 v51, v51, v40
    v_fmac_f32 v51, v50, v41
    v_fma_f32 v50, v50, v40, -v12
    v_cvt_pk_bf16_f32 v102, v50, v51
    v_mul_f32 v12, v51, v49
    v_mul_f32 v51, v51, v48
    v_fmac_f32 v51, v50, v49
    v_fma_f32 v50, v50, v48, -v12
    v_cvt_pk_bf16_f32 v103, v50, v51
    v_mul_f32 v12, v51, v43
    v_mul_f32 v51, v51, v42
    v_fmac_f32 v51, v50, v43
    v_fma_f32 v50, v50, v42, -v12
    v_cvt_pk_bf16_f32 v104, v50, v51
    v_mul_f32 v12, v51, v43
    v_mul_f32 v51, v51, v42
    v_fmac_f32 v51, v50, v43
    v_fma_f32 v50, v50, v42, -v12
    v_cvt_pk_bf16_f32 v105, v50, v51
    v_mul_f32 v12, v51, v43
    v_mul_f32 v51, v51, v42
    v_fmac_f32 v51, v50, v43
    v_fma_f32 v50, v50, v42, -v12
    v_cvt_pk_bf16_f32 v106, v50, v51
    v_mul_f32 v12, v51, v43
    v_mul_f32 v51, v51, v42
    v_fmac_f32 v51, v50, v43
    v_fma_f32 v50, v50, v42, -v12
    v_cvt_pk_bf16_f32 v107, v50, v51
    v_mul_f32 v12, v51, v49
    v_mul_f32 v51, v51, v48
    v_fmac_f32 v51, v50, v49
    v_fma_f32 v50, v50, v48, -v12
    v_cvt_pk_bf16_f32 v108, v50, v51
    v_mul_f32 v12, v51, v45
    v_mul_f32 v51, v51, v44
    v_fmac_f32 v51, v50, v45
    v_fma_f32 v50, v50, v44, -v12
    v_cvt_pk_bf16_f32 v109, v50, v51
    v_mul_f32 v12, v51, v45
    v_mul_f32 v51, v51, v44
    v_fmac_f32 v51, v50, v45
    v_fma_f32 v50, v50, v44, -v12
    v_cvt_pk_bf16_f32 v110, v50, v51
    v_mul_f32 v12, v51, v49
    v_mul_f32 v51, v51, v48
    v_fmac_f32 v51, v50, v49
    v_fma_f32 v50, v50, v48, -v12
    v_cvt_pk_bf16_f32 v111, v50, v51
    v_mul_f32 v12, v51, v45
    v_mul_f32 v51, v51, v44
    v_fmac_f32 v51, v50, v45
    v_fma_f32 v50, v50, v44, -v12
    v_cvt_pk_bf16_f32 v112, v50, v51
    v_mul_f32 v12, v51, v45
    v_mul_f32 v51, v51, v44
    v_fmac_f32 v51, v50, v45
    v_fma_f32 v50, v50, v44, -v12
    s_cmp_ge_u32 s2, 224
    s_cbranch_scc1 L_gb13
    s_barrier
    L_gb13:
    v_cvt_pk_bf16_f32 v113, v50, v51
    v_mul_f32 v12, v51, v49
    v_mul_f32 v51, v51, v48
    v_fmac_f32 v51, v50, v49
    v_fma_f32 v50, v50, v48, -v12
    v_cvt_pk_bf16_f32 v114, v50, v51
    v_mul_f32 v12, v51, v47
    v_mul_f32 v51, v51, v46
    v_fmac_f32 v51, v50, v47
    v_fma_f32 v50, v50, v46, -v12
    v_cvt_pk_bf16_f32 v115, v50, v51
    v_mul_f32 v12, v51, v49
    v_mul_f32 v51, v51, v48
    v_fmac_f32 v51, v50, v49
    v_fma_f32 v50, v50, v48, -v12
    v_cvt_pk_bf16_f32 v116, v50, v51
    v_mul_f32 v12, v51, v47
    v_mul_f32 v51, v51, v46
    v_fmac_f32 v51, v50, v47
    v_fma_f32 v50, v50, v46, -v12
    v_cvt_pk_bf16_f32 v117, v50, v51
    v_mul_f32 v12, v51, v49
    v_mul_f32 v51, v51, v48
    v_fmac_f32 v51, v50, v49
    v_fma_f32 v50, v50, v48, -v12
    v_cvt_pk_bf16_f32 v118, v50, v51
    v_mul_f32 v12, v51, v47
    v_mul_f32 v51, v51, v46
    v_fmac_f32 v51, v50, v47
    v_fma_f32 v50, v50, v46, -v12
    v_cvt_pk_bf16_f32 v119, v50, v51
    v_mul_f32 v12, v51, v49
    v_mul_f32 v51, v51, v48
    v_fmac_f32 v51, v50, v49
    v_fma_f32 v50, v50, v48, -v12
    v_cvt_pk_bf16_f32 v120, v50, v51
    v_mul_f32 v12, v51, v47
    v_mul_f32 v51, v51, v46
    v_fmac_f32 v51, v50, v47
    v_fma_f32 v50, v50, v46, -v12
    v_cvt_pk_bf16_f32 v121, v50, v51
    v_mul_f32 v12, v51, v47
    v_mul_f32 v51, v51, v46
    v_fmac_f32 v51, v50, v47
    v_fma_f32 v50, v50, v46, -v12
    v_cvt_pk_bf16_f32 v122, v50, v51
    v_mul_f32 v12, v51, v47
    v_mul_f32 v51, v51, v46
    v_fmac_f32 v51, v50, v47
    v_fma_f32 v50, v50, v46, -v12
    v_cvt_pk_bf16_f32 v123, v50, v51
    v_mul_f32 v12, v51, v47
    v_mul_f32 v51, v51, v46
    v_fmac_f32 v51, v50, v47
    v_fma_f32 v50, v50, v46, -v12
    v_cvt_pk_bf16_f32 v124, v50, v51
    v_mul_f32 v12, v51, v47
    v_mul_f32 v51, v51, v46
    v_fmac_f32 v51, v50, v47
    v_fma_f32 v50, v50, v46, -v12
    v_cvt_pk_bf16_f32 v125, v50, v51
    s_waitcnt vmcnt(0)
    v_add_u32 v16, s49, v16
    v_add_u32 v17, s49, v17
    v_mov_b32 v4, 0
    v_mov_b32 v5, 0
    v_mov_b32 v6, 0
    v_mov_b32 v7, 0
    v_add_u32 v19, s67, v19
    v_lshl_add_u32 v9, v27, 7, v19
    v_lshl_add_u32 v10, v27, 8, v19
    s_cmp_ge_u32 s2, 224
    s_cbranch_scc1 L_gb14
    s_barrier
    s_barrier
    L_gb14:
    ds_write_addtid_b32 v62 offset:57344
    ds_write_addtid_b32 v63 offset:57616
    ds_write_addtid_b32 v64 offset:57888
    ds_write_addtid_b32 v65 offset:58160
    ds_write_addtid_b32 v66 offset:58432
    ds_write_addtid_b32 v67 offset:58704
    ds_write_addtid_b32 v68 offset:58976
    ds_write_addtid_b32 v69 offset:59248
    ds_write_addtid_b32 v70 offset:59520
    ds_write_addtid_b32 v71 offset:59792
    ds_write_addtid_b32 v72 offset:60064
    ds_write_addtid_b32 v73 offset:60336
    ds_write_addtid_b32 v74 offset:60608
    ds_write_addtid_b32 v75 offset:60880
    ds_write_addtid_b32 v76 offset:61152
    ds_write_addtid_b32 v77 offset:61424
    ds_write_addtid_b32 v78 offset:61696
    ds_write_addtid_b32 v79 offset:61968
    ds_write_addtid_b32 v80 offset:62240
    ds_write_addtid_b32 v81 offset:62512
    ds_write_addtid_b32 v82 offset:62784
    ds_write_addtid_b32 v83 offset:63056
    ds_write_addtid_b32 v84 offset:63328
    ds_write_addtid_b32 v85 offset:63600
    ds_write_addtid_b32 v86 offset:63872
    ds_write_addtid_b32 v87 offset:64144
    ds_write_addtid_b32 v88 offset:64416
    ds_write_addtid_b32 v89 offset:64688
    s_mov_b32 exec_lo, 0
    ds_write_addtid_b32 v90 offset:64960
    ds_write_addtid_b32 v91 offset:65232
    ds_write_addtid_b32 v92 offset:64832
    ds_write_addtid_b32 v93 offset:65104
    s_mov_b32 exec_lo, -1
    s_setprio 1
    ds_read_b128 v[62:65], v16 offset:0
    ds_read_b128 v[66:69], v17 offset:0
    ds_read_b128 v[70:73], v16 offset:32
    ds_read_b128 v[74:77], v17 offset:32
    ds_read_b128 v[78:81], v16 offset:64
    ds_read_b128 v[82:85], v17 offset:64
    ds_read_b128 v[86:89], v16 offset:96
    ds_read_b128 v[90:93], v17 offset:96
    ds_write_addtid_b32 v94 offset:57344
    ds_write_addtid_b32 v95 offset:57616
    ds_write_addtid_b32 v96 offset:57888
    ds_write_addtid_b32 v97 offset:58160
    ds_write_addtid_b32 v98 offset:58432
    ds_write_addtid_b32 v99 offset:58704
    ds_write_addtid_b32 v100 offset:58976
    ds_write_addtid_b32 v101 offset:59248
    ds_write_addtid_b32 v102 offset:59520
    ds_write_addtid_b32 v103 offset:59792
    ds_write_addtid_b32 v104 offset:60064
    ds_write_addtid_b32 v105 offset:60336
    ds_write_addtid_b32 v106 offset:60608
    ds_write_addtid_b32 v107 offset:60880
    ds_write_addtid_b32 v108 offset:61152
    ds_write_addtid_b32 v109 offset:61424
    ds_write_addtid_b32 v110 offset:61696
    ds_write_addtid_b32 v111 offset:61968
    ds_write_addtid_b32 v112 offset:62240
    ds_write_addtid_b32 v113 offset:62512
    ds_write_addtid_b32 v114 offset:62784
    ds_write_addtid_b32 v115 offset:63056
    ds_write_addtid_b32 v116 offset:63328
    ds_write_addtid_b32 v117 offset:63600
    ds_write_addtid_b32 v118 offset:63872
    ds_write_addtid_b32 v119 offset:64144
    ds_write_addtid_b32 v120 offset:64416
    ds_write_addtid_b32 v121 offset:64688
    s_mov_b32 exec_lo, 0
    ds_write_addtid_b32 v122 offset:64960
    ds_write_addtid_b32 v123 offset:65232
    ds_write_addtid_b32 v124 offset:64832
    ds_write_addtid_b32 v125 offset:65104
    s_mov_b32 exec_lo, -1
    ds_read_b128 v[94:97], v16 offset:0
    ds_read_b128 v[98:101], v17 offset:0
    ds_read_b128 v[102:105], v16 offset:32
    ds_read_b128 v[106:109], v17 offset:32
    ds_read_b128 v[110:113], v16 offset:64
    ds_read_b128 v[114:117], v17 offset:64
    ds_read_b128 v[118:121], v16 offset:96
    ds_read_b128 v[122:125], v17 offset:96
    s_waitcnt lgkmcnt(15)
    v_mfma_f32_32x32x16_bf16 v[46:61], v[62:65], v[66:69], 0
    v_mfma_f32_32x32x16_bf16 v[46:61], v[70:73], v[74:77], v[46:61]
    v_mfma_f32_32x32x16_bf16 v[46:61], v[78:81], v[82:85], v[46:61]
    v_mfma_f32_32x32x16_bf16 v[46:61], v[86:89], v[90:93], v[46:61]
    s_waitcnt lgkmcnt(6)
    v_mfma_f32_32x32x16_bf16 v[46:61], v[94:97], v[98:101], v[46:61]
    s_waitcnt lgkmcnt(4)
    v_mfma_f32_32x32x16_bf16 v[46:61], v[102:105], v[106:109], v[46:61]
    s_waitcnt lgkmcnt(2)
    v_mfma_f32_32x32x16_bf16 v[46:61], v[110:113], v[114:117], v[46:61]
    s_waitcnt lgkmcnt(0)
    v_mfma_f32_32x32x16_bf16 v[46:61], v[118:121], v[122:125], v[46:61]
    s_cmp_eq_u32 s63, 0
    s_cbranch_scc1 L_kg_h0
    s_nop 9
    ds_write_b128 v2, v[46:49] offset:0
    ds_write_b128 v2, v[50:53] offset:1024
    ds_write_b128 v2, v[54:57] offset:2048
    v_mov_b32 v12, 1
    s_mov_b64 exec, 1
    ds_write_b32 v3, v12 offset:64
    s_mov_b64 exec, -1
    ds_write_b128 v1, v[4:7] offset:0
    ds_write_b128 v1, v[4:7] offset:3104
    ds_write_b128 v1, v[4:7] offset:6208
    ds_write_b128 v1, v[4:7] offset:9312
    s_mov_b32 s71, 0x100000
    L_kx15:
    ds_read_b32 v12, v26 offset:64
    ds_read_b128 v[94:97], v11 offset:0
    s_sub_u32 s71, s71, 1
    s_cbranch_scc1 L_ke16
    s_waitcnt lgkmcnt(1)
    v_readfirstlane_b32 s69, v12
    s_cmp_eq_u32 s69, 0
    s_cbranch_scc1 L_kx15
    L_ke16:
    s_waitcnt lgkmcnt(0)
    v_add_f32 v58, v58, v94
    v_add_f32 v59, v59, v95
    v_add_f32 v60, v60, v96
    v_add_f32 v61, v61, v97
    v_cndmask_b32 v13, v58, v59, vcc
    v_cndmask_b32 v14, v60, v61, vcc
    v_cvt_pk_bf16_f32 v66, v59, v59
    v_cvt_pk_bf16_f32 v67, v59, v13
    v_cvt_pk_bf16_f32 v68, v58, v58
    v_cvt_pk_bf16_f32 v69, v58, v58
    v_cvt_pk_bf16_f32 v62, v59, v59
    v_cvt_pk_bf16_f32 v63, v13, v58
    v_cvt_pk_bf16_f32 v64, v58, v58
    v_cvt_pk_bf16_f32 v65, v58, v58
    ds_write_b128 v10, v[62:65] offset:512
    ds_write_b128 v10, v[66:69] offset:528
    v_cvt_pk_bf16_f32 v74, v61, v61
    v_cvt_pk_bf16_f32 v75, v61, v14
    v_cvt_pk_bf16_f32 v76, v60, v60
    v_cvt_pk_bf16_f32 v77, v60, v60
    v_cvt_pk_bf16_f32 v70, v61, v61
    v_cvt_pk_bf16_f32 v71, v14, v60
    v_cvt_pk_bf16_f32 v72, v60, v60
    v_cvt_pk_bf16_f32 v73, v60, v60
    ds_write_b128 v10, v[70:73] offset:640
    ds_write_b128 v10, v[74:77] offset:656
    s_branch L_kg_end
    L_kg_h0:
    s_nop 9
    ds_write_b128 v2, v[58:61] offset:0
    v_mov_b32 v12, 1
    s_mov_b64 exec, 1
    ds_write_b32 v3, v12 offset:64
    s_mov_b64 exec, -1
    s_mov_b32 s71, 0x100000
    L_kx17:
    ds_read_b32 v12, v26 offset:64
    ds_read_b128 v[94:97], v11 offset:0
    ds_read_b128 v[98:101], v11 offset:1024
    ds_read_b128 v[102:105], v11 offset:2048
    s_sub_u32 s71, s71, 1
    s_cbranch_scc1 L_ke18
    s_waitcnt lgkmcnt(3)
    v_readfirstlane_b32 s69, v12
    s_cmp_eq_u32 s69, 0
    s_cbranch_scc1 L_kx17
    L_ke18:
    s_waitcnt lgkmcnt(0)
    v_add_f32 v53, v53, v101
    ds_bpermute_b32 v12, v18, v53
    v_add_f32 v54, v54, v102
    v_add_f32 v55, v55, v103
    v_add_f32 v56, v56, v104
    v_cvt_pk_bf16_f32 v74, v56, v56
    v_cvt_pk_bf16_f32 v75, v55, v55
    v_cvt_pk_bf16_f32 v76, v55, v54
    v_cvt_pk_bf16_f32 v77, v54, v54
    v_cvt_pk_bf16_f32 v70, v56, v55
    v_cvt_pk_bf16_f32 v71, v55, v55
    v_cvt_pk_bf16_f32 v72, v54, v54
    v_cvt_pk_bf16_f32 v73, v54, v54
    ds_write_b128 v9, v[70:73] offset:256
    ds_write_b128 v9, v[74:77] offset:272
    v_add_f32 v46, v46, v94
    v_add_f32 v47, v47, v95
    v_add_f32 v48, v48, v96
    v_add_f32 v49, v49, v97
    v_add_f32 v50, v50, v98
    v_add_f32 v51, v51, v99
    v_add_f32 v52, v52, v100
    s_mov_b64 exec, 1
    v_add_f32 v46, v46, v21
    s_mov_b64 exec, -1
    v_cvt_pk_bf16_f32 v66, v53, v52
    v_cvt_pk_bf16_f32 v67, v51, v50
    v_cvt_pk_bf16_f32 v68, v49, v48
    v_cvt_pk_bf16_f32 v69, v47, v46
    v_cvt_pk_bf16_f32 v62, v52, v51
    v_cvt_pk_bf16_f32 v63, v50, v49
    v_cvt_pk_bf16_f32 v64, v48, v47
    s_waitcnt lgkmcnt(2)
    s_mov_b64 exec, 1
    v_mov_b32 v12, 0
    s_mov_b64 exec, -1
    v_cvt_pk_bf16_f32 v65, v46, v12
    ds_write_b128 v9, v[62:65] offset:0
    ds_write_b128 v9, v[66:69] offset:16
    L_kg_end:
    v_mov_b32 v15, 4
    s_mov_b64 exec, 1
    ds_write_b32 v3, v15 offset:32
    s_mov_b64 exec, -1
L_conv:
    s_mov_b32 s71, 0x100000
    s_mov_b32 s68, 0
    L_cv_w:
    ds_read_b64 v[132:133], v129 offset:32
    ds_read_b32 v134, v128 offset:16
    s_sub_u32 s71, s71, 1
    s_cbranch_scc1 L_cv_go
    s_waitcnt lgkmcnt(0)
    v_min3_u32 v132, v132, v133, v134
    v_cmp_gt_u32 vcc, 4, v132
    s_cbranch_vccnz L_cv_w
    L_cv_go:
    s_setprio 0
    s_bitcmp1_b32 s3, 1
    s_cbranch_scc1 L_cv_b
    ds_read_b128 v[4:7], v126 offset:0
    ds_read_b128 v[8:11], v127 offset:64
    ds_read_b128 v[12:15], v127 offset:576
    ds_read_b128 v[16:19], v126 offset:2048
    ds_read_b128 v[46:49], v126 offset:32
    ds_read_b128 v[50:53], v127 offset:3168
    ds_read_b128 v[54:57], v127 offset:3680
    ds_read_b128 v[58:61], v126 offset:2080
    ds_read_b128 v[94:97], v126 offset:64
    ds_read_b128 v[98:101], v127 offset:6272
    ds_read_b128 v[102:105], v127 offset:6784
    ds_read_b128 v[106:109], v126 offset:2112
    v_mov_b32 v62, 0
    v_mov_b32 v63, 0
    v_mov_b32 v64, 0
    v_mov_b32 v65, 0
    v_mov_b32 v66, 0
    v_mov_b32 v67, 0
    v_mov_b32 v68, 0
    v_mov_b32 v69, 0
    v_mov_b32 v70, 0
    v_mov_b32 v71, 0
    v_mov_b32 v72, 0
    v_mov_b32 v73, 0
    v_mov_b32 v74, 0
    v_mov_b32 v75, 0
    v_mov_b32 v76, 0
    v_mov_b32 v77, 0
    s_branch L_cv_loop
    L_cv_b:
    ds_read_b128 v[4:7], v131 offset:512
    ds_read_b128 v[8:11], v131 offset:2560
    ds_read_b128 v[50:53], v135 offset:224
    ds_read_b128 v[16:19], v131 offset:576
    ds_read_b128 v[46:49], v131 offset:2624
    ds_read_b128 v[94:97], v135 offset:6432
    ds_read_b128 v[54:57], v131 offset:640
    ds_read_b128 v[58:61], v131 offset:2688
    ds_read_b128 v[106:109], v135 offset:192
    ds_read_b128 v[98:101], v131 offset:704
    ds_read_b128 v[102:105], v131 offset:2752
    v_mov_b32 v62, 0
    v_mov_b32 v63, 0
    v_mov_b32 v64, 0
    v_mov_b32 v65, 0
    v_mov_b32 v66, 0
    v_mov_b32 v67, 0
    v_mov_b32 v68, 0
    v_mov_b32 v69, 0
    v_mov_b32 v70, 0
    v_mov_b32 v71, 0
    v_mov_b32 v72, 0
    v_mov_b32 v73, 0
    v_mov_b32 v74, 0
    v_mov_b32 v75, 0
    v_mov_b32 v76, 0
    v_mov_b32 v77, 0
    v_mov_b32 v78, 0
    v_mov_b32 v79, 0
    v_mov_b32 v80, 0
    v_mov_b32 v81, 0
    v_mov_b32 v82, 0
    v_mov_b32 v83, 0
    v_mov_b32 v84, 0
    v_mov_b32 v85, 0
    s_waitcnt lgkmcnt(6)
    v_mfma_f32_16x16x32_bf16 v[140:143], v[4:7], v[50:53], v[140:143]
    ds_read_b128 v[118:121], v135 offset:6400
    v_mfma_f32_16x16x32_bf16 v[156:159], v[8:11], v[50:53], v[156:159]
    ds_read_b128 v[110:113], v131 offset:768
    v_mfma_f32_16x16x32_bf16 v[148:151], v[16:19], v[50:53], v[148:151]
    ds_read_b128 v[114:117], v131 offset:2816
    v_mfma_f32_16x16x32_bf16 v[164:167], v[46:49], v[50:53], v[164:167]
    s_waitcnt lgkmcnt(6)
    v_mfma_f32_16x16x32_bf16 v[140:143], v[16:19], v[94:97], v[140:143]
    ds_read_b128 v[12:15], v135 offset:160
    v_mfma_f32_16x16x32_bf16 v[156:159], v[46:49], v[94:97], v[156:159]
    ds_read_b128 v[4:7], v131 offset:832
    v_mfma_f32_16x16x32_bf16 v[148:151], v[54:57], v[94:97], v[148:151]
    ds_read_b128 v[8:11], v131 offset:2880
    v_mfma_f32_16x16x32_bf16 v[164:167], v[58:61], v[94:97], v[164:167]
    s_waitcnt lgkmcnt(6)
    v_mfma_f32_16x16x32_bf16 v[140:143], v[54:57], v[106:109], v[140:143]
    ds_read_b128 v[50:53], v135 offset:6368
    v_mfma_f32_16x16x32_bf16 v[156:159], v[58:61], v[106:109], v[156:159]
    ds_read_b128 v[16:19], v131 offset:896
    v_mfma_f32_16x16x32_bf16 v[148:151], v[98:101], v[106:109], v[148:151]
    ds_read_b128 v[46:49], v131 offset:2944
    v_mfma_f32_16x16x32_bf16 v[164:167], v[102:105], v[106:109], v[164:167]
    s_waitcnt lgkmcnt(6)
    v_mfma_f32_16x16x32_bf16 v[140:143], v[98:101], v[118:121], v[140:143]
    ds_read_b128 v[94:97], v135 offset:128
    v_mfma_f32_16x16x32_bf16 v[156:159], v[102:105], v[118:121], v[156:159]
    ds_read_b128 v[54:57], v131 offset:960
    v_mfma_f32_16x16x32_bf16 v[148:151], v[110:113], v[118:121], v[148:151]
    ds_read_b128 v[58:61], v131 offset:3008
    v_mfma_f32_16x16x32_bf16 v[164:167], v[114:117], v[118:121], v[164:167]
    s_waitcnt lgkmcnt(6)
    v_mfma_f32_16x16x32_bf16 v[140:143], v[110:113], v[12:15], v[140:143]
    ds_read_b128 v[106:109], v135 offset:6336
    v_mfma_f32_16x16x32_bf16 v[156:159], v[114:117], v[12:15], v[156:159]
    ds_read_b128 v[98:101], v131 offset:1024
    v_mfma_f32_16x16x32_bf16 v[148:151], v[4:7], v[12:15], v[148:151]
    ds_read_b128 v[102:105], v131 offset:3072
    v_mfma_f32_16x16x32_bf16 v[164:167], v[8:11], v[12:15], v[164:167]
    s_waitcnt lgkmcnt(6)
    v_mfma_f32_16x16x32_bf16 v[140:143], v[4:7], v[50:53], v[140:143]
    ds_read_b128 v[118:121], v135 offset:96
    v_mfma_f32_16x16x32_bf16 v[156:159], v[8:11], v[50:53], v[156:159]
    ds_read_b128 v[110:113], v131 offset:1088
    v_mfma_f32_16x16x32_bf16 v[148:151], v[16:19], v[50:53], v[148:151]
    ds_read_b128 v[114:117], v131 offset:3136
    v_mfma_f32_16x16x32_bf16 v[164:167], v[46:49], v[50:53], v[164:167]
    s_waitcnt lgkmcnt(6)
    v_mfma_f32_16x16x32_bf16 v[140:143], v[16:19], v[94:97], v[140:143]
    ds_read_b128 v[12:15], v135 offset:6304
    v_mfma_f32_16x16x32_bf16 v[156:159], v[46:49], v[94:97], v[156:159]
    ds_read_b128 v[4:7], v131 offset:1152
    v_mfma_f32_16x16x32_bf16 v[148:151], v[54:57], v[94:97], v[148:151]
    ds_read_b128 v[8:11], v131 offset:3200
    v_mfma_f32_16x16x32_bf16 v[164:167], v[58:61], v[94:97], v[164:167]
    s_waitcnt lgkmcnt(6)
    v_mfma_f32_16x16x32_bf16 v[140:143], v[54:57], v[106:109], v[140:143]
    ds_read_b128 v[50:53], v135 offset:64
    v_mfma_f32_16x16x32_bf16 v[156:159], v[58:61], v[106:109], v[156:159]
    ds_read_b128 v[16:19], v131 offset:1216
    v_mfma_f32_16x16x32_bf16 v[148:151], v[98:101], v[106:109], v[148:151]
    ds_read_b128 v[46:49], v131 offset:3264
    v_mfma_f32_16x16x32_bf16 v[164:167], v[102:105], v[106:109], v[164:167]
    s_waitcnt lgkmcnt(6)
    v_mfma_f32_16x16x32_bf16 v[140:143], v[98:101], v[118:121], v[140:143]
    ds_read_b128 v[94:97], v135 offset:6272
    v_mfma_f32_16x16x32_bf16 v[156:159], v[102:105], v[118:121], v[156:159]
    ds_read_b128 v[54:57], v131 offset:1280
    v_mfma_f32_16x16x32_bf16 v[148:151], v[110:113], v[118:121], v[148:151]
    ds_read_b128 v[58:61], v131 offset:3328
    v_mfma_f32_16x16x32_bf16 v[164:167], v[114:117], v[118:121], v[164:167]
    s_waitcnt lgkmcnt(6)
    v_mfma_f32_16x16x32_bf16 v[140:143], v[110:113], v[12:15], v[140:143]
    ds_read_b128 v[106:109], v135 offset:32
    v_mfma_f32_16x16x32_bf16 v[156:159], v[114:117], v[12:15], v[156:159]
    ds_read_b128 v[98:101], v131 offset:1344
    v_mfma_f32_16x16x32_bf16 v[148:151], v[4:7], v[12:15], v[148:151]
    ds_read_b128 v[102:105], v131 offset:3392
    v_mfma_f32_16x16x32_bf16 v[164:167], v[8:11], v[12:15], v[164:167]
    s_waitcnt lgkmcnt(6)
    v_mfma_f32_16x16x32_bf16 v[140:143], v[4:7], v[50:53], v[140:143]
    ds_read_b128 v[118:121], v135 offset:6240
    v_mfma_f32_16x16x32_bf16 v[156:159], v[8:11], v[50:53], v[156:159]
    ds_read_b128 v[110:113], v131 offset:1408
    v_mfma_f32_16x16x32_bf16 v[148:151], v[16:19], v[50:53], v[148:151]
    ds_read_b128 v[114:117], v131 offset:3456
    v_mfma_f32_16x16x32_bf16 v[164:167], v[46:49], v[50:53], v[164:167]
    s_waitcnt lgkmcnt(6)
    v_mfma_f32_16x16x32_bf16 v[140:143], v[16:19], v[94:97], v[140:143]
    ds_read_b128 v[12:15], v135 offset:0
    v_mfma_f32_16x16x32_bf16 v[156:159], v[46:49], v[94:97], v[156:159]
    ds_read_b128 v[4:7], v131 offset:1472
    v_mfma_f32_16x16x32_bf16 v[148:151], v[54:57], v[94:97], v[148:151]
    ds_read_b128 v[8:11], v131 offset:3520
    v_mfma_f32_16x16x32_bf16 v[164:167], v[58:61], v[94:97], v[164:167]
    s_waitcnt lgkmcnt(6)
    v_mfma_f32_16x16x32_bf16 v[140:143], v[54:57], v[106:109], v[140:143]
    ds_read_b128 v[50:53], v135 offset:6208
    v_mfma_f32_16x16x32_bf16 v[156:159], v[58:61], v[106:109], v[156:159]
    ds_read_b128 v[16:19], v131 offset:1536
    v_mfma_f32_16x16x32_bf16 v[148:151], v[98:101], v[106:109], v[148:151]
    ds_read_b128 v[46:49], v131 offset:3584
    v_mfma_f32_16x16x32_bf16 v[164:167], v[102:105], v[106:109], v[164:167]
    s_waitcnt lgkmcnt(6)
    v_mfma_f32_16x16x32_bf16 v[140:143], v[98:101], v[118:121], v[140:143]
    v_mov_b32 v86, 0
    v_mfma_f32_16x16x32_bf16 v[156:159], v[102:105], v[118:121], v[156:159]
    v_mov_b32 v87, 0
    v_mfma_f32_16x16x32_bf16 v[148:151], v[110:113], v[118:121], v[148:151]
    v_mov_b32 v88, 0
    v_mfma_f32_16x16x32_bf16 v[164:167], v[114:117], v[118:121], v[164:167]
    s_waitcnt lgkmcnt(3)
    v_mfma_f32_16x16x32_bf16 v[140:143], v[110:113], v[12:15], v[140:143]
    v_mov_b32 v89, 0
    v_mfma_f32_16x16x32_bf16 v[156:159], v[114:117], v[12:15], v[156:159]
    v_mov_b32 v90, 0
    v_mfma_f32_16x16x32_bf16 v[148:151], v[4:7], v[12:15], v[148:151]
    v_mov_b32 v91, 0
    v_mfma_f32_16x16x32_bf16 v[164:167], v[8:11], v[12:15], v[164:167]
    s_waitcnt lgkmcnt(0)
    v_mfma_f32_16x16x32_bf16 v[140:143], v[4:7], v[50:53], v[140:143]
    v_mov_b32 v92, 0
    v_mfma_f32_16x16x32_bf16 v[156:159], v[8:11], v[50:53], v[156:159]
    v_mov_b32 v93, 0
    v_mfma_f32_16x16x32_bf16 v[148:151], v[16:19], v[50:53], v[148:151]
    v_mfma_f32_16x16x32_bf16 v[164:167], v[46:49], v[50:53], v[164:167]
    ds_read_b128 v[4:7], v126 offset:0
    ds_read_b128 v[8:11], v127 offset:64
    ds_read_b128 v[12:15], v127 offset:576
    ds_read_b128 v[16:19], v126 offset:2048
    ds_read_b128 v[46:49], v126 offset:32
    ds_read_b128 v[50:53], v127 offset:3168
    ds_read_b128 v[54:57], v127 offset:3680
    ds_read_b128 v[58:61], v126 offset:2080
    ds_read_b128 v[94:97], v126 offset:64
    ds_read_b128 v[98:101], v127 offset:6272
    ds_read_b128 v[102:105], v127 offset:6784
    ds_read_b128 v[106:109], v126 offset:2112
    v_permlane16_swap_b32 v136, v140
    v_permlane16_swap_b32 v137, v141
    v_permlane16_swap_b32 v138, v142
    v_permlane16_swap_b32 v139, v143
    v_permlane16_swap_b32 v144, v148
    v_permlane16_swap_b32 v145, v149
    v_permlane16_swap_b32 v146, v150
    v_permlane16_swap_b32 v147, v151
    v_permlane16_swap_b32 v152, v156
    v_permlane16_swap_b32 v153, v157
    v_permlane16_swap_b32 v154, v158
    v_permlane16_swap_b32 v155, v159
    v_permlane16_swap_b32 v160, v164
    v_permlane16_swap_b32 v161, v165
    v_permlane16_swap_b32 v162, v166
    v_permlane16_swap_b32 v163, v167
    s_nop 0
L_cv_loop:
    s_waitcnt lgkmcnt(8)
    v_mfma_f32_32x32x16_bf16 v[136:151], v[4:7], v[8:11], v[136:151]
    ds_read_b128 v[110:113], v126 offset:96
    ds_read_b128 v[114:117], v127 offset:9376
    v_mfma_f32_32x32x16_bf16 v[152:167], v[4:7], v[12:15], v[152:167]
    ds_read_b128 v[118:121], v127 offset:9888
    ds_read_b128 v[122:125], v126 offset:2144
    v_mfma_f32_32x32x16_bf16 v[152:167], v[16:19], v[8:11], v[152:167]
    s_waitcnt lgkmcnt(8)
    v_mfma_f32_32x32x16_bf16 v[136:151], v[46:49], v[50:53], v[136:151]
    ds_read_b128 v[4:7], v126 offset:128
    ds_read_b128 v[8:11], v127 offset:32
    v_mfma_f32_32x32x16_bf16 v[152:167], v[46:49], v[54:57], v[152:167]
    ds_read_b128 v[12:15], v127 offset:544
    ds_read_b128 v[16:19], v126 offset:2176
    v_mfma_f32_32x32x16_bf16 v[152:167], v[58:61], v[50:53], v[152:167]
    s_waitcnt lgkmcnt(8)
    v_mfma_f32_32x32x16_bf16 v[136:151], v[94:97], v[98:101], v[136:151]
    ds_read_b128 v[46:49], v126 offset:160
    ds_read_b128 v[50:53], v127 offset:3136
    v_mfma_f32_32x32x16_bf16 v[152:167], v[94:97], v[102:105], v[152:167]
    ds_read_b128 v[54:57], v127 offset:3648
    ds_read_b128 v[58:61], v126 offset:2208
    v_mfma_f32_32x32x16_bf16 v[152:167], v[106:109], v[98:101], v[152:167]
    s_waitcnt lgkmcnt(8)
    v_mfma_f32_32x32x16_bf16 v[136:151], v[110:113], v[114:117], v[136:151]
    ds_read_b128 v[94:97], v126 offset:192
    ds_read_b128 v[98:101], v127 offset:6240
    v_mfma_f32_32x32x16_bf16 v[152:167], v[110:113], v[118:121], v[152:167]
    ds_read_b128 v[102:105], v127 offset:6752
    ds_read_b128 v[106:109], v126 offset:2240
    v_mfma_f32_32x32x16_bf16 v[152:167], v[122:125], v[114:117], v[152:167]
    s_waitcnt lgkmcnt(8)
    v_mfma_f32_32x32x16_bf16 v[136:151], v[4:7], v[8:11], v[136:151]
    ds_read_b128 v[110:113], v126 offset:224
    ds_read_b128 v[114:117], v127 offset:9344
    v_mfma_f32_32x32x16_bf16 v[152:167], v[4:7], v[12:15], v[152:167]
    ds_read_b128 v[118:121], v127 offset:9856
    ds_read_b128 v[122:125], v126 offset:2272
    v_mfma_f32_32x32x16_bf16 v[152:167], v[16:19], v[8:11], v[152:167]
    s_waitcnt lgkmcnt(8)
    v_mfma_f32_32x32x16_bf16 v[136:151], v[46:49], v[50:53], v[136:151]
    ds_read_b128 v[4:7], v126 offset:256
    ds_read_b128 v[8:11], v127 offset:0
    v_mfma_f32_32x32x16_bf16 v[152:167], v[46:49], v[54:57], v[152:167]
    ds_read_b128 v[12:15], v127 offset:512
    ds_read_b128 v[16:19], v126 offset:2304
    v_mfma_f32_32x32x16_bf16 v[152:167], v[58:61], v[50:53], v[152:167]
    s_waitcnt lgkmcnt(8)
    v_mfma_f32_32x32x16_bf16 v[136:151], v[94:97], v[98:101], v[136:151]
    ds_read_b128 v[46:49], v126 offset:288
    ds_read_b128 v[50:53], v127 offset:3104
    v_mfma_f32_32x32x16_bf16 v[152:167], v[94:97], v[102:105], v[152:167]
    ds_read_b128 v[54:57], v127 offset:3616
    ds_read_b128 v[58:61], v126 offset:2336
    v_mfma_f32_32x32x16_bf16 v[152:167], v[106:109], v[98:101], v[152:167]
    s_waitcnt lgkmcnt(8)
    v_mfma_f32_32x32x16_bf16 v[136:151], v[110:113], v[114:117], v[136:151]
    ds_read_b128 v[94:97], v126 offset:320
    ds_read_b128 v[98:101], v127 offset:6208
    s_add_u32 s68, s68, 1
    s_cmp_lt_u32 s68, 2
    v_mfma_f32_32x32x16_bf16 v[152:167], v[110:113], v[118:121], v[152:167]
    ds_read_b128 v[102:105], v127 offset:6720
    ds_read_b128 v[106:109], v126 offset:2368
    v_add_u32 v126, 256, v126
    v_subrev_u32 v127, 64, v127
    v_mfma_f32_32x32x16_bf16 v[152:167], v[122:125], v[114:117], v[152:167]
    s_cbranch_scc1 L_cv_loop
    s_bitcmp1_b32 s3, 1
    s_cbranch_scc1 L_cv_e
    ds_read_b128 v[46:49], v126 offset:512
    ds_read_b128 v[50:53], v127 offset:448
    ds_read_b128 v[54:57], v126 offset:544
    ds_read_b128 v[58:61], v127 offset:3552
    ds_read_b128 v[94:97], v126 offset:576
    ds_read_b128 v[98:101], v127 offset:6656
    ds_read_b128 v[102:105], v126 offset:608
    ds_read_b128 v[106:109], v127 offset:9760
    ds_read_b128 v[4:7], v126 offset:640
    ds_read_b128 v[8:11], v127 offset:416
    v_mov_b32 v78, 0
    v_mov_b32 v79, 0
    v_mov_b32 v80, 0
    v_mov_b32 v81, 0
    v_mov_b32 v82, 0
    v_mov_b32 v83, 0
    v_mov_b32 v84, 0
    v_mov_b32 v85, 0
    v_mov_b32 v86, 0
    v_mov_b32 v87, 0
    v_mov_b32 v88, 0
    v_mov_b32 v89, 0
    v_mov_b32 v90, 0
    v_mov_b32 v91, 0
    v_mov_b32 v92, 0
    v_mov_b32 v93, 0
    s_waitcnt lgkmcnt(8)
    v_mfma_f32_32x32x16_bf16 v[152:167], v[46:49], v[50:53], v[152:167]
    ds_read_b128 v[12:15], v126 offset:672
    ds_read_b128 v[16:19], v127 offset:3520
    s_waitcnt lgkmcnt(8)
    v_mfma_f32_32x32x16_bf16 v[152:167], v[54:57], v[58:61], v[152:167]
    ds_read_b128 v[46:49], v126 offset:704
    ds_read_b128 v[50:53], v127 offset:6624
    s_waitcnt lgkmcnt(8)
    v_mfma_f32_32x32x16_bf16 v[152:167], v[94:97], v[98:101], v[152:167]
    ds_read_b128 v[54:57], v126 offset:736
    ds_read_b128 v[58:61], v127 offset:9728
    s_waitcnt lgkmcnt(8)
    v_mfma_f32_32x32x16_bf16 v[152:167], v[102:105], v[106:109], v[152:167]
    ds_read_b128 v[94:97], v126 offset:768
    ds_read_b128 v[98:101], v127 offset:384
    s_waitcnt lgkmcnt(8)
    v_mfma_f32_32x32x16_bf16 v[152:167], v[4:7], v[8:11], v[152:167]
    ds_read_b128 v[102:105], v126 offset:800
    ds_read_b128 v[106:109], v127 offset:3488
    s_waitcnt lgkmcnt(8)
    v_mfma_f32_32x32x16_bf16 v[152:167], v[12:15], v[16:19], v[152:167]
    ds_read_b128 v[4:7], v126 offset:832
    ds_read_b128 v[8:11], v127 offset:6592
    s_waitcnt lgkmcnt(8)
    v_mfma_f32_32x32x16_bf16 v[152:167], v[46:49], v[50:53], v[152:167]
    ds_read_b128 v[12:15], v126 offset:864
    ds_read_b128 v[16:19], v127 offset:9696
    s_waitcnt lgkmcnt(8)
    v_mfma_f32_32x32x16_bf16 v[152:167], v[54:57], v[58:61], v[152:167]
    ds_read_b128 v[46:49], v126 offset:896
    ds_read_b128 v[50:53], v127 offset:352
    s_waitcnt lgkmcnt(8)
    v_mfma_f32_32x32x16_bf16 v[152:167], v[94:97], v[98:101], v[152:167]
    ds_read_b128 v[54:57], v126 offset:928
    ds_read_b128 v[58:61], v127 offset:3456
    s_waitcnt lgkmcnt(8)
    v_mfma_f32_32x32x16_bf16 v[152:167], v[102:105], v[106:109], v[152:167]
    ds_read_b128 v[94:97], v126 offset:960
    ds_read_b128 v[98:101], v127 offset:6560
    s_waitcnt lgkmcnt(8)
    v_mfma_f32_32x32x16_bf16 v[152:167], v[4:7], v[8:11], v[152:167]
    ds_read_b128 v[102:105], v126 offset:992
    ds_read_b128 v[106:109], v127 offset:9664
    s_waitcnt lgkmcnt(8)
    v_mfma_f32_32x32x16_bf16 v[152:167], v[12:15], v[16:19], v[152:167]
    ds_read_b128 v[4:7], v126 offset:1024
    ds_read_b128 v[8:11], v127 offset:320
    s_waitcnt lgkmcnt(8)
    v_mfma_f32_32x32x16_bf16 v[152:167], v[46:49], v[50:53], v[152:167]
    ds_read_b128 v[12:15], v126 offset:1056
    ds_read_b128 v[16:19], v127 offset:3424
    s_waitcnt lgkmcnt(8)
    v_mfma_f32_32x32x16_bf16 v[152:167], v[54:57], v[58:61], v[152:167]
    ds_read_b128 v[46:49], v126 offset:1088
    ds_read_b128 v[50:53], v127 offset:6528
    s_waitcnt lgkmcnt(8)
    v_mfma_f32_32x32x16_bf16 v[152:167], v[94:97], v[98:101], v[152:167]
    ds_read_b128 v[54:57], v126 offset:1120
    ds_read_b128 v[58:61], v127 offset:9632
    s_waitcnt lgkmcnt(8)
    v_mfma_f32_32x32x16_bf16 v[152:167], v[102:105], v[106:109], v[152:167]
    ds_read_b128 v[94:97], v126 offset:1152
    ds_read_b128 v[98:101], v127 offset:288
    s_waitcnt lgkmcnt(8)
    v_mfma_f32_32x32x16_bf16 v[152:167], v[4:7], v[8:11], v[152:167]
    ds_read_b128 v[102:105], v126 offset:1184
    ds_read_b128 v[106:109], v127 offset:3392
    s_waitcnt lgkmcnt(8)
    v_mfma_f32_32x32x16_bf16 v[152:167], v[12:15], v[16:19], v[152:167]
    ds_read_b128 v[4:7], v126 offset:1216
    ds_read_b128 v[8:11], v127 offset:6496
    s_waitcnt lgkmcnt(8)
    v_mfma_f32_32x32x16_bf16 v[152:167], v[46:49], v[50:53], v[152:167]
    ds_read_b128 v[12:15], v126 offset:1248
    ds_read_b128 v[16:19], v127 offset:9600
    s_waitcnt lgkmcnt(8)
    v_mfma_f32_32x32x16_bf16 v[152:167], v[54:57], v[58:61], v[152:167]
    ds_read_b128 v[46:49], v126 offset:1280
    ds_read_b128 v[50:53], v127 offset:256
    s_waitcnt lgkmcnt(8)
    v_mfma_f32_32x32x16_bf16 v[152:167], v[94:97], v[98:101], v[152:167]
    ds_read_b128 v[54:57], v126 offset:1312
    ds_read_b128 v[58:61], v127 offset:3360
    s_waitcnt lgkmcnt(8)
    v_mfma_f32_32x32x16_bf16 v[152:167], v[102:105], v[106:109], v[152:167]
    ds_read_b128 v[94:97], v126 offset:1344
    ds_read_b128 v[98:101], v127 offset:6464
    s_waitcnt lgkmcnt(8)
    v_mfma_f32_32x32x16_bf16 v[152:167], v[4:7], v[8:11], v[152:167]
    ds_read_b128 v[102:105], v126 offset:1376
    ds_read_b128 v[106:109], v127 offset:9568
    s_waitcnt lgkmcnt(8)
    v_mfma_f32_32x32x16_bf16 v[152:167], v[12:15], v[16:19], v[152:167]
    ds_read_b128 v[4:7], v126 offset:1408
    ds_read_b128 v[8:11], v127 offset:224
    s_waitcnt lgkmcnt(8)
    v_mfma_f32_32x32x16_bf16 v[152:167], v[46:49], v[50:53], v[152:167]
    ds_read_b128 v[12:15], v126 offset:1440
    ds_read_b128 v[16:19], v127 offset:3328
    s_waitcnt lgkmcnt(8)
    v_mfma_f32_32x32x16_bf16 v[152:167], v[54:57], v[58:61], v[152:167]
    ds_read_b128 v[46:49], v126 offset:1472
    ds_read_b128 v[50:53], v127 offset:6432
    s_waitcnt lgkmcnt(8)
    v_mfma_f32_32x32x16_bf16 v[152:167], v[94:97], v[98:101], v[152:167]
    ds_read_b128 v[54:57], v126 offset:1504
    ds_read_b128 v[58:61], v127 offset:9536
    s_waitcnt lgkmcnt(8)
    v_mfma_f32_32x32x16_bf16 v[152:167], v[102:105], v[106:109], v[152:167]
    s_waitcnt lgkmcnt(6)
    v_mfma_f32_32x32x16_bf16 v[152:167], v[4:7], v[8:11], v[152:167]
    s_waitcnt lgkmcnt(4)
    v_mfma_f32_32x32x16_bf16 v[152:167], v[12:15], v[16:19], v[152:167]
    s_waitcnt lgkmcnt(2)
    v_mfma_f32_32x32x16_bf16 v[152:167], v[46:49], v[50:53], v[152:167]
    s_waitcnt lgkmcnt(0)
    v_mfma_f32_32x32x16_bf16 v[152:167], v[54:57], v[58:61], v[152:167]
    L_cv_e:
    s_waitcnt lgkmcnt(0)
    s_cmp_lt_u32 s3, 4
    s_cbranch_scc1 L_cv_s1
    s_setprio 3
    s_barrier
    s_branch L_at_qb
    L_cv_s1:
    s_lshl_b32 s63, s3, 2
    s_add_u32 s63, s63, 157792
    v_mov_b32 v132, s63
    v_mov_b32 v133, 1
    s_mov_b64 exec, 1
    ds_write_b32 v132, v133 offset:0
    s_mov_b64 exec, -1
    s_branch L_attn2
L_attn:
L_attn2:
    s_cmp_ge_u32 s3, 4
    s_cbranch_scc1 L_at_qb
    s_mul_i32 s58, s53, 73728
    s_add_u32 s60, s58, s55
    s_add_u32 s58, s58, s57
    s_add_u32 s59, s58, 72704
    v_lshlrev_b32 v22, 4, v0
    v_lshlrev_b32 v23, 2, v0
    v_lshrrev_b32 v36, 4, v0
    v_mul_u32_u24 v36, 73472, v36
    v_add_u32 v36, v36, v22
    s_mov_b32 m0, s54
    s_min_u32 s63, s55, s57
    s_add_u32 s64, s63, 1024
    s_lshr_b32 s63, s63, 12
    s_lshr_b32 s64, s64, 12
    s_lshr_b32 s65, s52, 1
    s_lshl_b32 s63, s63, 5
    s_lshl_b32 s64, s64, 5
    s_add_u32 s63, s63, s65
    s_add_u32 s64, s64, s65
    s_mul_i32 s63, s63, 128
    s_mul_i32 s64, s64, 128
    s_mul_i32 s65, s65, 128
    s_add_u32 s65, s65, 110592
    v_mov_b32 v32, s63
    v_writelane_b32 v32, s64, 1
    v_writelane_b32 v32, s65, 2
    s_mov_b32 s63, 17651840
    v_mov_b32 v33, 157696
    s_mov_b32 s71, 0x100000
    L_lp19:
    ds_read_b128 v[14:17], v33 offset:32
    s_sub_u32 s71, s71, 1
    s_cbranch_scc1 L_le20
    s_waitcnt lgkmcnt(0)
    v_min3_u32 v14, v14, v15, v16
    v_min_u32 v14, v14, v17
    s_nop 0
    v_readfirstlane_b32 s69, v14
    s_cmp_ge_u32 s69, 1
    s_cbranch_scc1 L_le20
    s_sleep 2
    s_branch L_lp19
    L_le20:
    s_mov_b64 exec, 7
    s_mov_b32 s71, 0x40000
    L_gp21:
    buffer_load_dword v33, v32, s[12:15], s63 offen sc1
    s_sub_u32 s71, s71, 1
    s_cbranch_scc1 L_ge22
    s_waitcnt vmcnt(0)
    v_xor_b32 v33, s70, v33
    v_cmp_ne_u32 vcc, 0, v33
    s_cbranch_vccz L_ge22
    s_sleep 2
    s_branch L_gp21
    L_ge22:
    s_mov_b64 exec, -1
    buffer_load_dwordx4 v22, s[12:15], s58 offen sc1 lds
    buffer_load_dwordx4 v22, s[12:15], s59 offen offset:1024 sc1 lds
    s_add_u32 m0, s54, 2048
    s_mov_b32 exec_hi, 0
    buffer_load_dwordx4 v36, s[12:15], s60 offen sc1 lds
    s_mov_b32 exec_hi, -1
    s_waitcnt vmcnt(0)
    ds_read2st64_b64 v[4:7], v35 offset0:0 offset1:1
    ds_read2st64_b64 v[8:11], v35 offset0:2 offset1:3
    s_branch L_at_cm
    L_at_qb:
    ds_read2st64_b64 v[8:11], v35 offset0:0 offset1:1
    ds_read2st64_b64 v[4:7], v35 offset0:2 offset1:3
    ds_read_b64 v[12:13], v34 offset:2048
    buffer_load_dword v31, v39, s[12:15], s62 offen offset:260 sc1
    buffer_load_dword v25, v39, s[12:15], s62 offen offset:4 sc1
    s_lshl_b32 s58, s52, 5
    s_add_u32 s58, s58, s96
    s_mul_i32 s58, s58, 128
    s_add_u32 s58, s58, 17389568
    v_mov_b32 v24, s70
    v_lshrrev_b32 v26, 5, v0
    v_mul_u32_u24 v26, 3968, v26
    v_lshl_add_u32 v26, v0, 2, v26
    v_lshlrev_b32 v22, 4, v0
    v_lshlrev_b32 v23, 2, v0
    s_branch L_at_go
    L_at_cm:
    ds_read_b64 v[12:13], v34 offset:2048
    s_barrier
    L_at_go:
    ds_read2st64_b64 v[18:21], v29 offset0:8 offset1:9
    ds_read2st64_b64 v[14:17], v29 offset0:0 offset1:1
    ds_read_b128 v[40:43], v30 offset:0
    s_cmp_eq_u32 s98, 0
    s_cbranch_scc1 L_at_nost2
    v_cvt_pk_bf16_f32 v48, v136, v137
    v_cvt_pk_bf16_f32 v49, v138, v139
    v_cvt_pk_bf16_f32 v50, v140, v141
    v_cvt_pk_bf16_f32 v51, v142, v143
    v_cvt_pk_bf16_f32 v52, v144, v145
    v_cvt_pk_bf16_f32 v53, v146, v147
    v_cvt_pk_bf16_f32 v54, v148, v149
    v_cvt_pk_bf16_f32 v55, v150, v151
    v_cvt_pk_bf16_f32 v102, v152, v153
    v_cvt_pk_bf16_f32 v103, v154, v155
    v_cvt_pk_bf16_f32 v104, v156, v157
    v_cvt_pk_bf16_f32 v105, v158, v159
    v_cvt_pk_bf16_f32 v106, v160, v161
    v_cvt_pk_bf16_f32 v107, v162, v163
    v_cvt_pk_bf16_f32 v108, v164, v165
    v_cvt_pk_bf16_f32 v109, v166, v167
    buffer_store_dwordx4 v[48:51], v130, s[12:15], s98 offen offset:0 sc1
    buffer_store_dwordx4 v[52:55], v130, s[12:15], s98 offen offset:1024 sc1
    buffer_store_dwordx4 v[102:105], v130, s[12:15], s98 offen offset:2048 sc1
    buffer_store_dwordx4 v[106:109], v130, s[12:15], s98 offen offset:3072 sc1
    L_at_nost2:
    s_cmp_eq_u32 s56, 0
    s_cselect_b32 s64, -1, 0
    s_not_b32 s65, s64
    s_waitcnt lgkmcnt(3)
    v_and_b32 v12, s64, v12
    v_and_b32 v13, s65, v13
    s_nop 0
    s_waitcnt lgkmcnt(2)
    v_mfma_f32_32x32x4_2b_bf16 v[136:167], v[18:19], v[12:13], 0 cbsz:1 abid:0
    s_mul_i32 s63, s51, 304
    s_lshl2_add_u32 s63, s3, s63
    s_add_u32 s63, s63, 149744
    v_mov_b32 v1, s63
    v_mov_b32 v2, 1
    s_cmp_lt_u32 s3, 4
    s_nop 9
    s_waitcnt lgkmcnt(1)
    s_setprio 2
    v_mfma_f32_32x32x16_bf16 v[94:109], v[14:17], v[4:7], v[136:151]
    s_nop 10
    s_cbranch_scc0 L_at_fb
    L_at_fb_ret:
    v_exp_f32 v94, v94
    v_exp_f32 v95, v95
    ds_read_b128 v[44:47], v30 offset:640
    v_exp_f32 v96, v96
    v_exp_f32 v97, v97
    v_exp_f32 v98, v98
    v_mfma_f32_32x32x16_bf16 v[110:125], v[14:17], v[8:11], v[152:167]
    s_waitcnt lgkmcnt(1)
    ds_read2st64_b64 v[14:17], v29 offset0:2 offset1:3
    v_exp_f32 v99, v99
    v_exp_f32 v100, v100
    v_exp_f32 v101, v101
    v_exp_f32 v102, v102
    v_exp_f32 v103, v103
    v_smfmac_f32_32x32x32_bf16 v[62:77], v[40:43], v[94:101], v28
    s_waitcnt lgkmcnt(1)
    v_exp_f32 v104, v104
    v_exp_f32 v105, v105
    v_exp_f32 v106, v106
    v_mfma_f32_32x32x4_2b_bf16 v[136:167], v[18:19], v[12:13], 0 cbsz:1 abid:1
    v_exp_f32 v107, v107
    v_exp_f32 v108, v108
    v_exp_f32 v109, v109
    v_exp_f32 v110, v110
    v_exp_f32 v111, v111
    v_exp_f32 v112, v112
    v_exp_f32 v113, v113
    v_exp_f32 v114, v114
    v_smfmac_f32_32x32x32_bf16 v[62:77], v[44:47], v[102:109], v28
    s_waitcnt lgkmcnt(0)
    v_exp_f32 v115, v115
    v_exp_f32 v116, v116
    v_exp_f32 v117, v117
    v_mfma_f32_32x32x16_bf16 v[94:109], v[14:17], v[4:7], v[136:151]
    v_exp_f32 v118, v118
    v_exp_f32 v119, v119
    v_exp_f32 v120, v120
    v_exp_f32 v121, v121
    v_smfmac_f32_32x32x32_bf16 v[78:93], v[40:43], v[110:117], v28
    ds_read_b128 v[40:43], v30 offset:1280
    v_exp_f32 v122, v122
    v_exp_f32 v123, v123
    v_exp_f32 v124, v124
    v_exp_f32 v125, v125
    v_exp_f32 v94, v94
    v_exp_f32 v95, v95
    v_smfmac_f32_32x32x32_bf16 v[78:93], v[44:47], v[118:125], v28
    ds_read_b128 v[44:47], v30 offset:1920
    v_exp_f32 v96, v96
    v_exp_f32 v97, v97
    v_exp_f32 v98, v98
    v_mfma_f32_32x32x16_bf16 v[110:125], v[14:17], v[8:11], v[152:167]
    s_waitcnt lgkmcnt(1)
    ds_read2st64_b64 v[14:17], v29 offset0:4 offset1:5
    v_exp_f32 v99, v99
    v_exp_f32 v100, v100
    v_exp_f32 v101, v101
    v_exp_f32 v102, v102
    v_exp_f32 v103, v103
    v_smfmac_f32_32x32x32_bf16 v[62:77], v[40:43], v[94:101], v28
    s_waitcnt lgkmcnt(1)
    v_exp_f32 v104, v104
    v_exp_f32 v105, v105
    v_exp_f32 v106, v106
    v_mfma_f32_32x32x4_2b_bf16 v[136:167], v[20:21], v[12:13], 0 cbsz:1 abid:0
    v_exp_f32 v107, v107
    v_exp_f32 v108, v108
    v_exp_f32 v109, v109
    v_exp_f32 v110, v110
    v_exp_f32 v111, v111
    v_exp_f32 v112, v112
    v_exp_f32 v113, v113
    v_exp_f32 v114, v114
    v_smfmac_f32_32x32x32_bf16 v[62:77], v[44:47], v[102:109], v28
    s_waitcnt lgkmcnt(0)
    v_exp_f32 v115, v115
    v_exp_f32 v116, v116
    v_exp_f32 v117, v117
    v_mfma_f32_32x32x16_bf16 v[94:109], v[14:17], v[4:7], v[136:151]
    v_exp_f32 v118, v118
    v_exp_f32 v119, v119
    v_exp_f32 v120, v120
    v_exp_f32 v121, v121
    v_smfmac_f32_32x32x32_bf16 v[78:93], v[40:43], v[110:117], v28
    ds_read_b128 v[40:43], v30 offset:2560
    v_exp_f32 v122, v122
    v_exp_f32 v123, v123
    v_exp_f32 v124, v124
    v_exp_f32 v125, v125
    v_exp_f32 v94, v94
    v_exp_f32 v95, v95
    v_smfmac_f32_32x32x32_bf16 v[78:93], v[44:47], v[118:125], v28
    ds_read_b128 v[44:47], v30 offset:3200
    v_exp_f32 v96, v96
    v_exp_f32 v97, v97
    v_exp_f32 v98, v98
    v_mfma_f32_32x32x16_bf16 v[110:125], v[14:17], v[8:11], v[152:167]
    s_waitcnt lgkmcnt(1)
    ds_read2st64_b64 v[14:17], v29 offset0:6 offset1:7
    v_exp_f32 v99, v99
    v_exp_f32 v100, v100
    v_exp_f32 v101, v101
    v_exp_f32 v102, v102
    v_exp_f32 v103, v103
    v_smfmac_f32_32x32x32_bf16 v[62:77], v[40:43], v[94:101], v28
    s_waitcnt lgkmcnt(1)
    v_exp_f32 v104, v104
    v_exp_f32 v105, v105
    v_exp_f32 v106, v106
    v_mfma_f32_32x32x4_2b_bf16 v[136:167], v[20:21], v[12:13], 0 cbsz:1 abid:1
    v_exp_f32 v107, v107
    v_exp_f32 v108, v108
    v_exp_f32 v109, v109
    v_exp_f32 v110, v110
    v_exp_f32 v111, v111
    v_exp_f32 v112, v112
    v_exp_f32 v113, v113
    v_exp_f32 v114, v114
    v_smfmac_f32_32x32x32_bf16 v[62:77], v[44:47], v[102:109], v28
    s_waitcnt lgkmcnt(0)
    s_cbranch_scc0 L_bl23
    s_barrier
    L_bl23:
    v_exp_f32 v115, v115
    v_exp_f32 v116, v116
    v_exp_f32 v117, v117
    v_mfma_f32_32x32x16_bf16 v[94:109], v[14:17], v[4:7], v[136:151]
    ds_read2st64_b64 v[18:21], v29 offset0:48 offset1:49
    v_exp_f32 v118, v118
    v_exp_f32 v119, v119
    v_exp_f32 v120, v120
    v_exp_f32 v121, v121
    v_smfmac_f32_32x32x32_bf16 v[78:93], v[40:43], v[110:117], v28
    ds_read_b128 v[40:43], v30 offset:3840
    v_exp_f32 v122, v122
    v_exp_f32 v123, v123
    v_exp_f32 v124, v124
    v_exp_f32 v125, v125
    v_exp_f32 v94, v94
    v_exp_f32 v95, v95
    v_smfmac_f32_32x32x32_bf16 v[78:93], v[44:47], v[118:125], v28
    ds_read_b128 v[44:47], v30 offset:4480
    v_exp_f32 v96, v96
    v_exp_f32 v97, v97
    v_exp_f32 v98, v98
    v_mfma_f32_32x32x16_bf16 v[110:125], v[14:17], v[8:11], v[152:167]
    s_waitcnt lgkmcnt(1)
    ds_read2st64_b64 v[14:17], v29 offset0:40 offset1:41
    v_exp_f32 v99, v99
    v_exp_f32 v100, v100
    v_exp_f32 v101, v101
    v_exp_f32 v102, v102
    v_exp_f32 v103, v103
    v_smfmac_f32_32x32x32_bf16 v[62:77], v[40:43], v[94:101], v28
    s_waitcnt lgkmcnt(1)
    v_exp_f32 v104, v104
    v_exp_f32 v105, v105
    v_exp_f32 v106, v106
    v_mfma_f32_32x32x4_2b_bf16 v[136:167], v[18:19], v[12:13], 0 cbsz:1 abid:0
    v_exp_f32 v107, v107
    v_exp_f32 v108, v108
    v_exp_f32 v109, v109
    v_exp_f32 v110, v110
    v_exp_f32 v111, v111
    v_exp_f32 v112, v112
    v_exp_f32 v113, v113
    v_exp_f32 v114, v114
    v_smfmac_f32_32x32x32_bf16 v[62:77], v[44:47], v[102:109], v28
    s_waitcnt lgkmcnt(0)
    v_exp_f32 v115, v115
    v_exp_f32 v116, v116
    v_exp_f32 v117, v117
    v_mfma_f32_32x32x16_bf16 v[94:109], v[14:17], v[4:7], v[136:151]
    v_exp_f32 v118, v118
    v_exp_f32 v119, v119
    v_exp_f32 v120, v120
    v_exp_f32 v121, v121
    v_smfmac_f32_32x32x32_bf16 v[78:93], v[40:43], v[110:117], v28
    ds_read_b128 v[40:43], v30 offset:20480
    v_exp_f32 v122, v122
    v_exp_f32 v123, v123
    v_exp_f32 v124, v124
    v_exp_f32 v125, v125
    v_exp_f32 v94, v94
    v_exp_f32 v95, v95
    v_smfmac_f32_32x32x32_bf16 v[78:93], v[44:47], v[118:125], v28
    ds_read_b128 v[44:47], v30 offset:21120
    v_exp_f32 v96, v96
    v_exp_f32 v97, v97
    v_exp_f32 v98, v98
    v_mfma_f32_32x32x16_bf16 v[110:125], v[14:17], v[8:11], v[152:167]
    s_waitcnt lgkmcnt(1)
    ds_read2st64_b64 v[14:17], v29 offset0:42 offset1:43
    v_exp_f32 v99, v99
    v_exp_f32 v100, v100
    v_exp_f32 v101, v101
    v_exp_f32 v102, v102
    v_exp_f32 v103, v103
    v_smfmac_f32_32x32x32_bf16 v[62:77], v[40:43], v[94:101], v28
    s_waitcnt lgkmcnt(1)
    v_exp_f32 v104, v104
    v_exp_f32 v105, v105
    v_exp_f32 v106, v106
    v_mfma_f32_32x32x4_2b_bf16 v[136:167], v[18:19], v[12:13], 0 cbsz:1 abid:1
    v_exp_f32 v107, v107
    v_exp_f32 v108, v108
    v_exp_f32 v109, v109
    v_exp_f32 v110, v110
    v_exp_f32 v111, v111
    v_exp_f32 v112, v112
    v_exp_f32 v113, v113
    v_exp_f32 v114, v114
    v_smfmac_f32_32x32x32_bf16 v[62:77], v[44:47], v[102:109], v28
    s_waitcnt lgkmcnt(0)
    v_exp_f32 v115, v115
    v_exp_f32 v116, v116
    v_exp_f32 v117, v117
    v_mfma_f32_32x32x16_bf16 v[94:109], v[14:17], v[4:7], v[136:151]
    v_exp_f32 v118, v118
    v_exp_f32 v119, v119
    v_exp_f32 v120, v120
    v_exp_f32 v121, v121
    v_smfmac_f32_32x32x32_bf16 v[78:93], v[40:43], v[110:117], v28
    ds_read_b128 v[40:43], v30 offset:21760
    v_exp_f32 v122, v122
    v_exp_f32 v123, v123
    v_exp_f32 v124, v124
    v_exp_f32 v125, v125
    v_exp_f32 v94, v94
    v_exp_f32 v95, v95
    v_smfmac_f32_32x32x32_bf16 v[78:93], v[44:47], v[118:125], v28
    ds_read_b128 v[44:47], v30 offset:22400
    v_exp_f32 v96, v96
    v_exp_f32 v97, v97
    v_exp_f32 v98, v98
    v_mfma_f32_32x32x16_bf16 v[110:125], v[14:17], v[8:11], v[152:167]
    s_waitcnt lgkmcnt(1)
    ds_read2st64_b64 v[14:17], v29 offset0:44 offset1:45
    v_exp_f32 v99, v99
    v_exp_f32 v100, v100
    v_exp_f32 v101, v101
    v_exp_f32 v102, v102
    v_exp_f32 v103, v103
    v_smfmac_f32_32x32x32_bf16 v[62:77], v[40:43], v[94:101], v28
    s_waitcnt lgkmcnt(1)
    v_exp_f32 v104, v104
    v_exp_f32 v105, v105
    v_exp_f32 v106, v106
    v_mfma_f32_32x32x4_2b_bf16 v[136:167], v[20:21], v[12:13], 0 cbsz:1 abid:0
    v_exp_f32 v107, v107
    v_exp_f32 v108, v108
    v_exp_f32 v109, v109
    v_exp_f32 v110, v110
    v_exp_f32 v111, v111
    v_exp_f32 v112, v112
    v_exp_f32 v113, v113
    v_exp_f32 v114, v114
    v_smfmac_f32_32x32x32_bf16 v[62:77], v[44:47], v[102:109], v28
    s_waitcnt lgkmcnt(0)
    v_exp_f32 v115, v115
    v_exp_f32 v116, v116
    v_exp_f32 v117, v117
    v_mfma_f32_32x32x16_bf16 v[94:109], v[14:17], v[4:7], v[136:151]
    v_exp_f32 v118, v118
    v_exp_f32 v119, v119
    v_exp_f32 v120, v120
    v_exp_f32 v121, v121
    v_smfmac_f32_32x32x32_bf16 v[78:93], v[40:43], v[110:117], v28
    s_cbranch_scc0 L_dp24
    s_setprio 1
    L_dp24:
    ds_read_b128 v[40:43], v30 offset:23040
    v_exp_f32 v122, v122
    v_exp_f32 v123, v123
    v_exp_f32 v124, v124
    v_exp_f32 v125, v125
    v_exp_f32 v94, v94
    v_exp_f32 v95, v95
    v_smfmac_f32_32x32x32_bf16 v[78:93], v[44:47], v[118:125], v28
    ds_read_b128 v[44:47], v30 offset:23680
    v_exp_f32 v96, v96
    v_exp_f32 v97, v97
    v_exp_f32 v98, v98
    v_mfma_f32_32x32x16_bf16 v[110:125], v[14:17], v[8:11], v[152:167]
    s_waitcnt lgkmcnt(1)
    ds_read2st64_b64 v[14:17], v29 offset0:46 offset1:47
    v_exp_f32 v99, v99
    v_exp_f32 v100, v100
    v_exp_f32 v101, v101
    v_exp_f32 v102, v102
    v_exp_f32 v103, v103
    v_smfmac_f32_32x32x32_bf16 v[62:77], v[40:43], v[94:101], v28
    s_waitcnt lgkmcnt(1)
    v_exp_f32 v104, v104
    v_exp_f32 v105, v105
    v_exp_f32 v106, v106
    v_mfma_f32_32x32x4_2b_bf16 v[136:167], v[20:21], v[12:13], 0 cbsz:1 abid:1
    v_exp_f32 v107, v107
    v_exp_f32 v108, v108
    v_exp_f32 v109, v109
    v_exp_f32 v110, v110
    v_exp_f32 v111, v111
    v_exp_f32 v112, v112
    v_exp_f32 v113, v113
    v_exp_f32 v114, v114
    v_smfmac_f32_32x32x32_bf16 v[62:77], v[44:47], v[102:109], v28
    s_waitcnt lgkmcnt(0)
    s_waitcnt vmcnt(0)
    s_barrier
    s_setprio 2
    v_exp_f32 v115, v115
    v_exp_f32 v116, v116
    v_exp_f32 v117, v117
    v_mfma_f32_32x32x16_bf16 v[94:109], v[14:17], v[4:7], v[136:151]
    ds_read2st64_b64 v[18:21], v29 offset0:88 offset1:89
    v_exp_f32 v118, v118
    v_exp_f32 v119, v119
    v_exp_f32 v120, v120
    v_exp_f32 v121, v121
    v_smfmac_f32_32x32x32_bf16 v[78:93], v[40:43], v[110:117], v28
    ds_read_b128 v[40:43], v30 offset:24320
    v_exp_f32 v122, v122
    v_exp_f32 v123, v123
    v_exp_f32 v124, v124
    v_exp_f32 v125, v125
    v_exp_f32 v94, v94
    v_exp_f32 v95, v95
    v_smfmac_f32_32x32x32_bf16 v[78:93], v[44:47], v[118:125], v28
    ds_read_b128 v[44:47], v30 offset:24960
    v_exp_f32 v96, v96
    v_exp_f32 v97, v97
    v_exp_f32 v98, v98
    v_mfma_f32_32x32x16_bf16 v[110:125], v[14:17], v[8:11], v[152:167]
    s_waitcnt lgkmcnt(1)
    ds_read2st64_b64 v[14:17], v29 offset0:80 offset1:81
    v_exp_f32 v99, v99
    v_exp_f32 v100, v100
    v_exp_f32 v101, v101
    v_exp_f32 v102, v102
    v_exp_f32 v103, v103
    v_smfmac_f32_32x32x32_bf16 v[62:77], v[40:43], v[94:101], v28
    s_waitcnt lgkmcnt(1)
    v_exp_f32 v104, v104
    v_exp_f32 v105, v105
    v_exp_f32 v106, v106
    v_mfma_f32_32x32x4_2b_bf16 v[136:167], v[18:19], v[12:13], 0 cbsz:1 abid:0
    v_exp_f32 v107, v107
    v_exp_f32 v108, v108
    v_exp_f32 v109, v109
    v_exp_f32 v110, v110
    v_exp_f32 v111, v111
    v_exp_f32 v112, v112
    v_exp_f32 v113, v113
    v_exp_f32 v114, v114
    v_smfmac_f32_32x32x32_bf16 v[62:77], v[44:47], v[102:109], v28
    s_waitcnt lgkmcnt(0)
    v_exp_f32 v115, v115
    v_exp_f32 v116, v116
    v_exp_f32 v117, v117
    v_mfma_f32_32x32x16_bf16 v[94:109], v[14:17], v[4:7], v[136:151]
    v_exp_f32 v118, v118
    v_exp_f32 v119, v119
    v_exp_f32 v120, v120
    v_exp_f32 v121, v121
    v_smfmac_f32_32x32x32_bf16 v[78:93], v[40:43], v[110:117], v28
    ds_read_b128 v[40:43], v30 offset:40960
    v_exp_f32 v122, v122
    v_exp_f32 v123, v123
    v_exp_f32 v124, v124
    v_exp_f32 v125, v125
    v_exp_f32 v94, v94
    v_exp_f32 v95, v95
    v_smfmac_f32_32x32x32_bf16 v[78:93], v[44:47], v[118:125], v28
    ds_read_b128 v[44:47], v30 offset:41600
    v_exp_f32 v96, v96
    v_exp_f32 v97, v97
    v_exp_f32 v98, v98
    v_mfma_f32_32x32x16_bf16 v[110:125], v[14:17], v[8:11], v[152:167]
    s_waitcnt lgkmcnt(1)
    ds_read2st64_b64 v[14:17], v29 offset0:82 offset1:83
    v_exp_f32 v99, v99
    v_exp_f32 v100, v100
    v_exp_f32 v101, v101
    v_exp_f32 v102, v102
    v_exp_f32 v103, v103
    v_smfmac_f32_32x32x32_bf16 v[62:77], v[40:43], v[94:101], v28
    s_waitcnt lgkmcnt(1)
    v_exp_f32 v104, v104
    v_exp_f32 v105, v105
    v_exp_f32 v106, v106
    v_mfma_f32_32x32x4_2b_bf16 v[136:167], v[18:19], v[12:13], 0 cbsz:1 abid:1
    v_exp_f32 v107, v107
    v_exp_f32 v108, v108
    v_exp_f32 v109, v109
    v_exp_f32 v110, v110
    v_exp_f32 v111, v111
    v_exp_f32 v112, v112
    v_exp_f32 v113, v113
    v_exp_f32 v114, v114
    v_smfmac_f32_32x32x32_bf16 v[62:77], v[44:47], v[102:109], v28
    s_waitcnt lgkmcnt(0)
    v_exp_f32 v115, v115
    v_exp_f32 v116, v116
    v_exp_f32 v117, v117
    v_mfma_f32_32x32x16_bf16 v[94:109], v[14:17], v[4:7], v[136:151]
    v_exp_f32 v118, v118
    v_exp_f32 v119, v119
    v_exp_f32 v120, v120
    v_exp_f32 v121, v121
    v_smfmac_f32_32x32x32_bf16 v[78:93], v[40:43], v[110:117], v28
    ds_read_b128 v[40:43], v30 offset:42240
    v_exp_f32 v122, v122
    v_exp_f32 v123, v123
    v_exp_f32 v124, v124
    v_exp_f32 v125, v125
    v_exp_f32 v94, v94
    v_exp_f32 v95, v95
    v_smfmac_f32_32x32x32_bf16 v[78:93], v[44:47], v[118:125], v28
    ds_read_b128 v[44:47], v30 offset:42880
    v_exp_f32 v96, v96
    v_exp_f32 v97, v97
    v_exp_f32 v98, v98
    v_mfma_f32_32x32x16_bf16 v[110:125], v[14:17], v[8:11], v[152:167]
    s_waitcnt lgkmcnt(1)
    ds_read2st64_b64 v[14:17], v29 offset0:84 offset1:85
    v_exp_f32 v99, v99
    v_exp_f32 v100, v100
    v_exp_f32 v101, v101
    v_exp_f32 v102, v102
    v_exp_f32 v103, v103
    v_smfmac_f32_32x32x32_bf16 v[62:77], v[40:43], v[94:101], v28
    s_waitcnt lgkmcnt(1)
    v_exp_f32 v104, v104
    v_exp_f32 v105, v105
    v_exp_f32 v106, v106
    v_mfma_f32_32x32x4_2b_bf16 v[136:167], v[20:21], v[12:13], 0 cbsz:1 abid:0
    v_exp_f32 v107, v107
    v_exp_f32 v108, v108
    v_exp_f32 v109, v109
    v_exp_f32 v110, v110
    v_exp_f32 v111, v111
    v_exp_f32 v112, v112
    v_exp_f32 v113, v113
    v_exp_f32 v114, v114
    v_smfmac_f32_32x32x32_bf16 v[62:77], v[44:47], v[102:109], v28
    s_waitcnt lgkmcnt(0)
    v_exp_f32 v115, v115
    v_exp_f32 v116, v116
    v_exp_f32 v117, v117
    v_mfma_f32_32x32x16_bf16 v[94:109], v[14:17], v[4:7], v[136:151]
    v_exp_f32 v118, v118
    v_exp_f32 v119, v119
    v_exp_f32 v120, v120
    v_exp_f32 v121, v121
    v_smfmac_f32_32x32x32_bf16 v[78:93], v[40:43], v[110:117], v28
    ds_read_b128 v[40:43], v30 offset:43520
    v_exp_f32 v122, v122
    v_exp_f32 v123, v123
    v_exp_f32 v124, v124
    v_exp_f32 v125, v125
    v_exp_f32 v94, v94
    v_exp_f32 v95, v95
    v_smfmac_f32_32x32x32_bf16 v[78:93], v[44:47], v[118:125], v28
    ds_read_b128 v[44:47], v30 offset:44160
    v_exp_f32 v96, v96
    v_exp_f32 v97, v97
    v_exp_f32 v98, v98
    v_mfma_f32_32x32x16_bf16 v[110:125], v[14:17], v[8:11], v[152:167]
    s_waitcnt lgkmcnt(1)
    ds_read2st64_b64 v[14:17], v29 offset0:86 offset1:87
    v_exp_f32 v99, v99
    v_exp_f32 v100, v100
    v_exp_f32 v101, v101
    v_exp_f32 v102, v102
    v_exp_f32 v103, v103
    v_smfmac_f32_32x32x32_bf16 v[62:77], v[40:43], v[94:101], v28
    s_waitcnt lgkmcnt(1)
    v_exp_f32 v104, v104
    v_exp_f32 v105, v105
    v_exp_f32 v106, v106
    v_mfma_f32_32x32x4_2b_bf16 v[136:167], v[20:21], v[12:13], 0 cbsz:1 abid:1
    v_exp_f32 v107, v107
    v_exp_f32 v108, v108
    v_exp_f32 v109, v109
    v_exp_f32 v110, v110
    v_exp_f32 v111, v111
    v_exp_f32 v112, v112
    v_exp_f32 v113, v113
    v_exp_f32 v114, v114
    v_smfmac_f32_32x32x32_bf16 v[62:77], v[44:47], v[102:109], v28
    s_waitcnt lgkmcnt(0)
    v_exp_f32 v115, v115
    v_exp_f32 v116, v116
    v_exp_f32 v117, v117
    v_mfma_f32_32x32x16_bf16 v[94:109], v[14:17], v[4:7], v[136:151]
    ds_read2st64_b64 v[18:21], v29 offset0:128 offset1:129
    v_exp_f32 v118, v118
    v_exp_f32 v119, v119
    v_exp_f32 v120, v120
    v_exp_f32 v121, v121
    v_smfmac_f32_32x32x32_bf16 v[78:93], v[40:43], v[110:117], v28
    ds_read_b128 v[40:43], v30 offset:44800
    v_exp_f32 v122, v122
    v_exp_f32 v123, v123
    v_exp_f32 v124, v124
    v_exp_f32 v125, v125
    v_exp_f32 v94, v94
    v_exp_f32 v95, v95
    v_smfmac_f32_32x32x32_bf16 v[78:93], v[44:47], v[118:125], v28
    ds_read_b128 v[44:47], v30 offset:45440
    v_exp_f32 v96, v96
    v_exp_f32 v97, v97
    v_exp_f32 v98, v98
    v_mfma_f32_32x32x16_bf16 v[110:125], v[14:17], v[8:11], v[152:167]
    s_waitcnt lgkmcnt(1)
    ds_read2st64_b64 v[14:17], v29 offset0:120 offset1:121
    v_exp_f32 v99, v99
    v_exp_f32 v100, v100
    v_exp_f32 v101, v101
    v_exp_f32 v102, v102
    v_exp_f32 v103, v103
    v_smfmac_f32_32x32x32_bf16 v[62:77], v[40:43], v[94:101], v28
    s_waitcnt lgkmcnt(1)
    v_exp_f32 v104, v104
    v_exp_f32 v105, v105
    v_exp_f32 v106, v106
    v_mfma_f32_32x32x4_2b_bf16 v[136:167], v[18:19], v[12:13], 0 cbsz:1 abid:0
    v_add_u32 v30, 61440, v30
    v_exp_f32 v107, v107
    v_exp_f32 v108, v108
    v_exp_f32 v109, v109
    v_exp_f32 v110, v110
    v_exp_f32 v111, v111
    v_exp_f32 v112, v112
    v_exp_f32 v113, v113
    v_exp_f32 v114, v114
    v_smfmac_f32_32x32x32_bf16 v[62:77], v[44:47], v[102:109], v28
    s_waitcnt lgkmcnt(0)
    v_exp_f32 v115, v115
    v_exp_f32 v116, v116
    v_exp_f32 v117, v117
    v_mfma_f32_32x32x16_bf16 v[94:109], v[14:17], v[4:7], v[136:151]
    v_exp_f32 v118, v118
    v_exp_f32 v119, v119
    v_exp_f32 v120, v120
    v_exp_f32 v121, v121
    v_smfmac_f32_32x32x32_bf16 v[78:93], v[40:43], v[110:117], v28
    ds_read_b128 v[40:43], v30 offset:0
    v_exp_f32 v122, v122
    v_exp_f32 v123, v123
    v_exp_f32 v124, v124
    v_exp_f32 v125, v125
    v_exp_f32 v94, v94
    v_exp_f32 v95, v95
    v_smfmac_f32_32x32x32_bf16 v[78:93], v[44:47], v[118:125], v28
    ds_read_b128 v[44:47], v30 offset:640
    v_exp_f32 v96, v96
    v_exp_f32 v97, v97
    v_exp_f32 v98, v98
    v_mfma_f32_32x32x16_bf16 v[110:125], v[14:17], v[8:11], v[152:167]
    s_waitcnt lgkmcnt(1)
    ds_read2st64_b64 v[14:17], v29 offset0:122 offset1:123
    v_exp_f32 v99, v99
    v_exp_f32 v100, v100
    v_exp_f32 v101, v101
    v_exp_f32 v102, v102
    v_exp_f32 v103, v103
    v_smfmac_f32_32x32x32_bf16 v[62:77], v[40:43], v[94:101], v28
    s_waitcnt lgkmcnt(1)
    v_exp_f32 v104, v104
    v_exp_f32 v105, v105
    v_exp_f32 v106, v106
    v_mfma_f32_32x32x4_2b_bf16 v[136:167], v[18:19], v[12:13], 0 cbsz:1 abid:1
    v_exp_f32 v107, v107
    v_exp_f32 v108, v108
    v_exp_f32 v109, v109
    v_exp_f32 v110, v110
    v_exp_f32 v111, v111
    v_exp_f32 v112, v112
    v_exp_f32 v113, v113
    v_exp_f32 v114, v114
    v_smfmac_f32_32x32x32_bf16 v[62:77], v[44:47], v[102:109], v28
    s_waitcnt lgkmcnt(0)
    v_exp_f32 v115, v115
    v_exp_f32 v116, v116
    v_exp_f32 v117, v117
    v_mfma_f32_32x32x16_bf16 v[94:109], v[14:17], v[4:7], v[136:151]
    v_exp_f32 v118, v118
    v_exp_f32 v119, v119
    v_exp_f32 v120, v120
    v_exp_f32 v121, v121
    v_smfmac_f32_32x32x32_bf16 v[78:93], v[40:43], v[110:117], v28
    ds_read_b128 v[40:43], v30 offset:1280
    v_exp_f32 v122, v122
    v_exp_f32 v123, v123
    v_exp_f32 v124, v124
    v_exp_f32 v125, v125
    v_exp_f32 v94, v94
    v_exp_f32 v95, v95
    v_smfmac_f32_32x32x32_bf16 v[78:93], v[44:47], v[118:125], v28
    ds_read_b128 v[44:47], v30 offset:1920
    v_exp_f32 v96, v96
    v_exp_f32 v97, v97
    v_exp_f32 v98, v98
    v_mfma_f32_32x32x16_bf16 v[110:125], v[14:17], v[8:11], v[152:167]
    s_waitcnt lgkmcnt(1)
    ds_read2st64_b64 v[14:17], v29 offset0:124 offset1:125
    v_exp_f32 v99, v99
    v_exp_f32 v100, v100
    v_exp_f32 v101, v101
    v_exp_f32 v102, v102
    v_exp_f32 v103, v103
    v_smfmac_f32_32x32x32_bf16 v[62:77], v[40:43], v[94:101], v28
    s_waitcnt lgkmcnt(1)
    v_exp_f32 v104, v104
    v_exp_f32 v105, v105
    v_exp_f32 v106, v106
    v_mfma_f32_32x32x4_2b_bf16 v[136:167], v[20:21], v[12:13], 0 cbsz:1 abid:0
    v_exp_f32 v107, v107
    v_exp_f32 v108, v108
    v_exp_f32 v109, v109
    v_exp_f32 v110, v110
    v_exp_f32 v111, v111
    v_exp_f32 v112, v112
    v_exp_f32 v113, v113
    v_exp_f32 v114, v114
    v_smfmac_f32_32x32x32_bf16 v[62:77], v[44:47], v[102:109], v28
    s_waitcnt lgkmcnt(0)
    v_exp_f32 v115, v115
    v_exp_f32 v116, v116
    v_exp_f32 v117, v117
    v_mfma_f32_32x32x16_bf16 v[94:109], v[14:17], v[4:7], v[136:151]
    v_exp_f32 v118, v118
    v_exp_f32 v119, v119
    v_exp_f32 v120, v120
    v_exp_f32 v121, v121
    v_smfmac_f32_32x32x32_bf16 v[78:93], v[40:43], v[110:117], v28
    s_cbranch_scc0 L_dp25
    s_setprio 1
    L_dp25:
    ds_read_b128 v[40:43], v30 offset:2560
    v_exp_f32 v122, v122
    v_exp_f32 v123, v123
    v_exp_f32 v124, v124
    v_exp_f32 v125, v125
    v_exp_f32 v94, v94
    v_exp_f32 v95, v95
    v_smfmac_f32_32x32x32_bf16 v[78:93], v[44:47], v[118:125], v28
    ds_read_b128 v[44:47], v30 offset:3200
    v_exp_f32 v96, v96
    v_exp_f32 v97, v97
    v_exp_f32 v98, v98
    v_mfma_f32_32x32x16_bf16 v[110:125], v[14:17], v[8:11], v[152:167]
    s_waitcnt lgkmcnt(1)
    ds_read2st64_b64 v[14:17], v29 offset0:126 offset1:127
    v_exp_f32 v99, v99
    v_exp_f32 v100, v100
    v_exp_f32 v101, v101
    v_exp_f32 v102, v102
    v_exp_f32 v103, v103
    v_smfmac_f32_32x32x32_bf16 v[62:77], v[40:43], v[94:101], v28
    s_waitcnt lgkmcnt(1)
    v_exp_f32 v104, v104
    v_exp_f32 v105, v105
    v_exp_f32 v106, v106
    v_mfma_f32_32x32x4_2b_bf16 v[136:167], v[20:21], v[12:13], 0 cbsz:1 abid:1
    v_exp_f32 v107, v107
    v_exp_f32 v108, v108
    v_exp_f32 v109, v109
    v_exp_f32 v110, v110
    v_exp_f32 v111, v111
    v_exp_f32 v112, v112
    v_exp_f32 v113, v113
    v_exp_f32 v114, v114
    v_smfmac_f32_32x32x32_bf16 v[62:77], v[44:47], v[102:109], v28
    s_waitcnt lgkmcnt(0)
    s_waitcnt vmcnt(0)
    s_barrier
    s_setprio 2
    v_exp_f32 v115, v115
    v_exp_f32 v116, v116
    v_exp_f32 v117, v117
    v_mfma_f32_32x32x16_bf16 v[94:109], v[14:17], v[4:7], v[136:151]
    ds_read2st64_b64 v[18:21], v29 offset0:168 offset1:169
    v_exp_f32 v118, v118
    v_exp_f32 v119, v119
    v_exp_f32 v120, v120
    v_exp_f32 v121, v121
    v_smfmac_f32_32x32x32_bf16 v[78:93], v[40:43], v[110:117], v28
    ds_read_b128 v[40:43], v30 offset:3840
    v_exp_f32 v122, v122
    v_exp_f32 v123, v123
    v_exp_f32 v124, v124
    v_exp_f32 v125, v125
    v_exp_f32 v94, v94
    v_exp_f32 v95, v95
    v_smfmac_f32_32x32x32_bf16 v[78:93], v[44:47], v[118:125], v28
    ds_read_b128 v[44:47], v30 offset:4480
    v_exp_f32 v96, v96
    v_exp_f32 v97, v97
    v_exp_f32 v98, v98
    v_mfma_f32_32x32x16_bf16 v[110:125], v[14:17], v[8:11], v[152:167]
    s_waitcnt lgkmcnt(1)
    ds_read2st64_b64 v[14:17], v29 offset0:160 offset1:161
    v_exp_f32 v99, v99
    v_exp_f32 v100, v100
    v_exp_f32 v101, v101
    v_exp_f32 v102, v102
    v_exp_f32 v103, v103
    v_smfmac_f32_32x32x32_bf16 v[62:77], v[40:43], v[94:101], v28
    s_waitcnt lgkmcnt(1)
    v_exp_f32 v104, v104
    v_exp_f32 v105, v105
    v_exp_f32 v106, v106
    v_mfma_f32_32x32x4_2b_bf16 v[136:167], v[18:19], v[12:13], 0 cbsz:1 abid:0
    v_exp_f32 v107, v107
    v_exp_f32 v108, v108
    v_exp_f32 v109, v109
    v_exp_f32 v110, v110
    v_exp_f32 v111, v111
    v_exp_f32 v112, v112
    v_exp_f32 v113, v113
    v_exp_f32 v114, v114
    v_smfmac_f32_32x32x32_bf16 v[62:77], v[44:47], v[102:109], v28
    s_waitcnt lgkmcnt(0)
    v_exp_f32 v115, v115
    v_exp_f32 v116, v116
    v_exp_f32 v117, v117
    v_mfma_f32_32x32x16_bf16 v[94:109], v[14:17], v[4:7], v[136:151]
    v_exp_f32 v118, v118
    v_exp_f32 v119, v119
    v_exp_f32 v120, v120
    v_exp_f32 v121, v121
    v_smfmac_f32_32x32x32_bf16 v[78:93], v[40:43], v[110:117], v28
    ds_read_b128 v[40:43], v30 offset:20480
    v_exp_f32 v122, v122
    v_exp_f32 v123, v123
    v_exp_f32 v124, v124
    v_exp_f32 v125, v125
    v_exp_f32 v94, v94
    v_exp_f32 v95, v95
    v_smfmac_f32_32x32x32_bf16 v[78:93], v[44:47], v[118:125], v28
    ds_read_b128 v[44:47], v30 offset:21120
    v_exp_f32 v96, v96
    v_exp_f32 v97, v97
    v_exp_f32 v98, v98
    v_mfma_f32_32x32x16_bf16 v[110:125], v[14:17], v[8:11], v[152:167]
    s_waitcnt lgkmcnt(1)
    ds_read2st64_b64 v[14:17], v29 offset0:162 offset1:163
    v_exp_f32 v99, v99
    v_exp_f32 v100, v100
    v_exp_f32 v101, v101
    v_exp_f32 v102, v102
    v_exp_f32 v103, v103
    v_smfmac_f32_32x32x32_bf16 v[62:77], v[40:43], v[94:101], v28
    s_waitcnt lgkmcnt(1)
    v_exp_f32 v104, v104
    v_exp_f32 v105, v105
    v_exp_f32 v106, v106
    v_mfma_f32_32x32x4_2b_bf16 v[136:167], v[18:19], v[12:13], 0 cbsz:1 abid:1
    v_exp_f32 v107, v107
    v_exp_f32 v108, v108
    v_exp_f32 v109, v109
    v_exp_f32 v110, v110
    v_exp_f32 v111, v111
    v_exp_f32 v112, v112
    v_exp_f32 v113, v113
    v_exp_f32 v114, v114
    v_smfmac_f32_32x32x32_bf16 v[62:77], v[44:47], v[102:109], v28
    s_waitcnt lgkmcnt(0)
    v_exp_f32 v115, v115
    v_exp_f32 v116, v116
    v_exp_f32 v117, v117
    v_mfma_f32_32x32x16_bf16 v[94:109], v[14:17], v[4:7], v[136:151]
    v_exp_f32 v118, v118
    v_exp_f32 v119, v119
    v_exp_f32 v120, v120
    v_exp_f32 v121, v121
    v_smfmac_f32_32x32x32_bf16 v[78:93], v[40:43], v[110:117], v28
    ds_read_b128 v[40:43], v30 offset:21760
    v_exp_f32 v122, v122
    v_exp_f32 v123, v123
    v_exp_f32 v124, v124
    v_exp_f32 v125, v125
    v_exp_f32 v94, v94
    v_exp_f32 v95, v95
    v_smfmac_f32_32x32x32_bf16 v[78:93], v[44:47], v[118:125], v28
    ds_read_b128 v[44:47], v30 offset:22400
    v_exp_f32 v96, v96
    v_exp_f32 v97, v97
    v_exp_f32 v98, v98
    v_mfma_f32_32x32x16_bf16 v[110:125], v[14:17], v[8:11], v[152:167]
    s_waitcnt lgkmcnt(1)
    ds_read2st64_b64 v[14:17], v29 offset0:164 offset1:165
    v_exp_f32 v99, v99
    v_exp_f32 v100, v100
    v_exp_f32 v101, v101
    v_exp_f32 v102, v102
    v_exp_f32 v103, v103
    v_smfmac_f32_32x32x32_bf16 v[62:77], v[40:43], v[94:101], v28
    s_waitcnt lgkmcnt(1)
    v_exp_f32 v104, v104
    v_exp_f32 v105, v105
    v_exp_f32 v106, v106
    v_mfma_f32_32x32x4_2b_bf16 v[136:167], v[20:21], v[12:13], 0 cbsz:1 abid:0
    v_exp_f32 v107, v107
    v_exp_f32 v108, v108
    v_exp_f32 v109, v109
    v_exp_f32 v110, v110
    v_exp_f32 v111, v111
    v_exp_f32 v112, v112
    v_exp_f32 v113, v113
    v_exp_f32 v114, v114
    v_smfmac_f32_32x32x32_bf16 v[62:77], v[44:47], v[102:109], v28
    s_waitcnt lgkmcnt(0)
    v_exp_f32 v115, v115
    v_exp_f32 v116, v116
    v_exp_f32 v117, v117
    v_mfma_f32_32x32x16_bf16 v[94:109], v[14:17], v[4:7], v[136:151]
    v_exp_f32 v118, v118
    v_exp_f32 v119, v119
    v_exp_f32 v120, v120
    v_exp_f32 v121, v121
    v_smfmac_f32_32x32x32_bf16 v[78:93], v[40:43], v[110:117], v28
    ds_read_b128 v[40:43], v30 offset:23040
    v_exp_f32 v122, v122
    v_exp_f32 v123, v123
    v_exp_f32 v124, v124
    v_exp_f32 v125, v125
    v_exp_f32 v94, v94
    v_exp_f32 v95, v95
    v_smfmac_f32_32x32x32_bf16 v[78:93], v[44:47], v[118:125], v28
    ds_read_b128 v[44:47], v30 offset:23680
    v_exp_f32 v96, v96
    v_exp_f32 v97, v97
    v_exp_f32 v98, v98
    v_mfma_f32_32x32x16_bf16 v[110:125], v[14:17], v[8:11], v[152:167]
    s_waitcnt lgkmcnt(1)
    ds_read2st64_b64 v[14:17], v29 offset0:166 offset1:167
    v_exp_f32 v99, v99
    v_exp_f32 v100, v100
    v_exp_f32 v101, v101
    v_exp_f32 v102, v102
    v_exp_f32 v103, v103
    v_smfmac_f32_32x32x32_bf16 v[62:77], v[40:43], v[94:101], v28
    s_waitcnt lgkmcnt(1)
    v_exp_f32 v104, v104
    v_exp_f32 v105, v105
    v_exp_f32 v106, v106
    v_mfma_f32_32x32x4_2b_bf16 v[136:167], v[20:21], v[12:13], 0 cbsz:1 abid:1
    v_exp_f32 v107, v107
    v_exp_f32 v108, v108
    v_exp_f32 v109, v109
    v_exp_f32 v110, v110
    v_exp_f32 v111, v111
    v_exp_f32 v112, v112
    v_exp_f32 v113, v113
    v_exp_f32 v114, v114
    v_smfmac_f32_32x32x32_bf16 v[62:77], v[44:47], v[102:109], v28
    s_waitcnt lgkmcnt(0)
    v_exp_f32 v115, v115
    v_exp_f32 v116, v116
    v_exp_f32 v117, v117
    v_mfma_f32_32x32x16_bf16 v[94:109], v[14:17], v[4:7], v[136:151]
    ds_read2st64_b64 v[18:21], v29 offset0:208 offset1:209
    v_exp_f32 v118, v118
    v_exp_f32 v119, v119
    v_exp_f32 v120, v120
    v_exp_f32 v121, v121
    v_smfmac_f32_32x32x32_bf16 v[78:93], v[40:43], v[110:117], v28
    ds_read_b128 v[40:43], v30 offset:24320
    v_exp_f32 v122, v122
    v_exp_f32 v123, v123
    v_exp_f32 v124, v124
    v_exp_f32 v125, v125
    v_exp_f32 v94, v94
    v_exp_f32 v95, v95
    v_smfmac_f32_32x32x32_bf16 v[78:93], v[44:47], v[118:125], v28
    ds_read_b128 v[44:47], v30 offset:24960
    v_exp_f32 v96, v96
    v_exp_f32 v97, v97
    v_exp_f32 v98, v98
    v_mfma_f32_32x32x16_bf16 v[110:125], v[14:17], v[8:11], v[152:167]
    s_waitcnt lgkmcnt(1)
    ds_read2st64_b64 v[14:17], v29 offset0:200 offset1:201
    v_exp_f32 v99, v99
    v_exp_f32 v100, v100
    v_exp_f32 v101, v101
    v_exp_f32 v102, v102
    v_exp_f32 v103, v103
    v_smfmac_f32_32x32x32_bf16 v[62:77], v[40:43], v[94:101], v28
    s_waitcnt lgkmcnt(1)
    v_exp_f32 v104, v104
    v_exp_f32 v105, v105
    v_exp_f32 v106, v106
    v_mfma_f32_32x32x4_2b_bf16 v[136:167], v[18:19], v[12:13], 0 cbsz:1 abid:0
    v_exp_f32 v107, v107
    v_exp_f32 v108, v108
    v_exp_f32 v109, v109
    v_exp_f32 v110, v110
    v_exp_f32 v111, v111
    v_exp_f32 v112, v112
    v_exp_f32 v113, v113
    v_exp_f32 v114, v114
    v_smfmac_f32_32x32x32_bf16 v[62:77], v[44:47], v[102:109], v28
    s_waitcnt lgkmcnt(0)
    v_exp_f32 v115, v115
    v_exp_f32 v116, v116
    v_exp_f32 v117, v117
    v_mfma_f32_32x32x16_bf16 v[94:109], v[14:17], v[4:7], v[136:151]
    v_exp_f32 v118, v118
    v_exp_f32 v119, v119
    v_exp_f32 v120, v120
    v_exp_f32 v121, v121
    v_smfmac_f32_32x32x32_bf16 v[78:93], v[40:43], v[110:117], v28
    ds_read_b128 v[40:43], v30 offset:40960
    v_exp_f32 v122, v122
    v_exp_f32 v123, v123
    v_exp_f32 v124, v124
    v_exp_f32 v125, v125
    v_exp_f32 v94, v94
    v_exp_f32 v95, v95
    v_smfmac_f32_32x32x32_bf16 v[78:93], v[44:47], v[118:125], v28
    ds_read_b128 v[44:47], v30 offset:41600
    v_exp_f32 v96, v96
    v_exp_f32 v97, v97
    v_exp_f32 v98, v98
    v_mfma_f32_32x32x16_bf16 v[110:125], v[14:17], v[8:11], v[152:167]
    s_waitcnt lgkmcnt(1)
    ds_read2st64_b64 v[14:17], v29 offset0:202 offset1:203
    v_exp_f32 v99, v99
    v_exp_f32 v100, v100
    v_exp_f32 v101, v101
    v_exp_f32 v102, v102
    v_exp_f32 v103, v103
    v_smfmac_f32_32x32x32_bf16 v[62:77], v[40:43], v[94:101], v28
    s_waitcnt lgkmcnt(1)
    v_exp_f32 v104, v104
    v_exp_f32 v105, v105
    v_exp_f32 v106, v106
    v_mfma_f32_32x32x4_2b_bf16 v[136:167], v[18:19], v[12:13], 0 cbsz:1 abid:1
    v_exp_f32 v107, v107
    v_exp_f32 v108, v108
    v_exp_f32 v109, v109
    v_exp_f32 v110, v110
    v_exp_f32 v111, v111
    v_exp_f32 v112, v112
    v_exp_f32 v113, v113
    v_exp_f32 v114, v114
    v_smfmac_f32_32x32x32_bf16 v[62:77], v[44:47], v[102:109], v28
    s_waitcnt lgkmcnt(0)
    v_exp_f32 v115, v115
    v_exp_f32 v116, v116
    v_exp_f32 v117, v117
    v_mfma_f32_32x32x16_bf16 v[94:109], v[14:17], v[4:7], v[136:151]
    v_exp_f32 v118, v118
    v_exp_f32 v119, v119
    v_exp_f32 v120, v120
    v_exp_f32 v121, v121
    v_smfmac_f32_32x32x32_bf16 v[78:93], v[40:43], v[110:117], v28
    ds_read_b128 v[40:43], v30 offset:42240
    v_exp_f32 v122, v122
    v_exp_f32 v123, v123
    v_exp_f32 v124, v124
    v_exp_f32 v125, v125
    v_exp_f32 v94, v94
    v_exp_f32 v95, v95
    v_smfmac_f32_32x32x32_bf16 v[78:93], v[44:47], v[118:125], v28
    ds_read_b128 v[44:47], v30 offset:42880
    v_exp_f32 v96, v96
    v_exp_f32 v97, v97
    v_exp_f32 v98, v98
    v_mfma_f32_32x32x16_bf16 v[110:125], v[14:17], v[8:11], v[152:167]
    s_waitcnt lgkmcnt(1)
    ds_read2st64_b64 v[14:17], v29 offset0:204 offset1:205
    v_exp_f32 v99, v99
    v_exp_f32 v100, v100
    v_exp_f32 v101, v101
    v_exp_f32 v102, v102
    v_exp_f32 v103, v103
    v_smfmac_f32_32x32x32_bf16 v[62:77], v[40:43], v[94:101], v28
    s_waitcnt lgkmcnt(1)
    v_exp_f32 v104, v104
    v_exp_f32 v105, v105
    v_exp_f32 v106, v106
    v_mfma_f32_32x32x4_2b_bf16 v[136:167], v[20:21], v[12:13], 0 cbsz:1 abid:0
    v_exp_f32 v107, v107
    v_exp_f32 v108, v108
    v_exp_f32 v109, v109
    v_exp_f32 v110, v110
    v_exp_f32 v111, v111
    v_exp_f32 v112, v112
    v_exp_f32 v113, v113
    v_exp_f32 v114, v114
    v_smfmac_f32_32x32x32_bf16 v[62:77], v[44:47], v[102:109], v28
    s_waitcnt lgkmcnt(0)
    v_exp_f32 v115, v115
    v_exp_f32 v116, v116
    v_exp_f32 v117, v117
    v_mfma_f32_32x32x16_bf16 v[94:109], v[14:17], v[4:7], v[136:151]
    v_exp_f32 v118, v118
    v_exp_f32 v119, v119
    v_exp_f32 v120, v120
    v_exp_f32 v121, v121
    v_smfmac_f32_32x32x32_bf16 v[78:93], v[40:43], v[110:117], v28
    ds_read_b128 v[40:43], v30 offset:43520
    v_exp_f32 v122, v122
    v_exp_f32 v123, v123
    v_exp_f32 v124, v124
    v_exp_f32 v125, v125
    v_exp_f32 v94, v94
    v_exp_f32 v95, v95
    v_smfmac_f32_32x32x32_bf16 v[78:93], v[44:47], v[118:125], v28
    ds_read_b128 v[44:47], v30 offset:44160
    v_exp_f32 v96, v96
    v_exp_f32 v97, v97
    v_exp_f32 v98, v98
    v_mfma_f32_32x32x16_bf16 v[110:125], v[14:17], v[8:11], v[152:167]
    s_waitcnt lgkmcnt(1)
    ds_read2st64_b64 v[14:17], v29 offset0:206 offset1:207
    v_exp_f32 v99, v99
    v_exp_f32 v100, v100
    v_exp_f32 v101, v101
    v_exp_f32 v102, v102
    v_exp_f32 v103, v103
    v_smfmac_f32_32x32x32_bf16 v[62:77], v[40:43], v[94:101], v28
    s_waitcnt lgkmcnt(1)
    v_exp_f32 v104, v104
    v_exp_f32 v105, v105
    v_exp_f32 v106, v106
    v_mfma_f32_32x32x4_2b_bf16 v[136:167], v[20:21], v[12:13], 0 cbsz:1 abid:1
    v_exp_f32 v107, v107
    v_exp_f32 v108, v108
    v_exp_f32 v109, v109
    v_exp_f32 v110, v110
    v_exp_f32 v111, v111
    v_exp_f32 v112, v112
    v_exp_f32 v113, v113
    v_exp_f32 v114, v114
    v_smfmac_f32_32x32x32_bf16 v[62:77], v[44:47], v[102:109], v28
    s_waitcnt lgkmcnt(0)
    v_exp_f32 v115, v115
    v_exp_f32 v116, v116
    v_exp_f32 v117, v117
    v_mfma_f32_32x32x16_bf16 v[94:109], v[14:17], v[4:7], v[136:151]
    ds_read2st64_b64 v[18:21], v29 offset0:248 offset1:249
    v_exp_f32 v118, v118
    v_exp_f32 v119, v119
    v_exp_f32 v120, v120
    v_exp_f32 v121, v121
    v_smfmac_f32_32x32x32_bf16 v[78:93], v[40:43], v[110:117], v28
    ds_read_b128 v[40:43], v30 offset:44800
    v_exp_f32 v122, v122
    v_exp_f32 v123, v123
    v_exp_f32 v124, v124
    v_exp_f32 v125, v125
    v_exp_f32 v94, v94
    v_exp_f32 v95, v95
    v_smfmac_f32_32x32x32_bf16 v[78:93], v[44:47], v[118:125], v28
    ds_read_b128 v[44:47], v30 offset:45440
    v_exp_f32 v96, v96
    v_exp_f32 v97, v97
    v_exp_f32 v98, v98
    v_mfma_f32_32x32x16_bf16 v[110:125], v[14:17], v[8:11], v[152:167]
    s_waitcnt lgkmcnt(1)
    ds_read2st64_b64 v[14:17], v29 offset0:240 offset1:241
    v_exp_f32 v99, v99
    v_exp_f32 v100, v100
    v_exp_f32 v101, v101
    v_exp_f32 v102, v102
    v_exp_f32 v103, v103
    v_smfmac_f32_32x32x32_bf16 v[62:77], v[40:43], v[94:101], v28
    s_waitcnt lgkmcnt(1)
    v_exp_f32 v104, v104
    v_exp_f32 v105, v105
    v_exp_f32 v106, v106
    v_mfma_f32_32x32x4_2b_bf16 v[136:167], v[18:19], v[12:13], 0 cbsz:1 abid:0
    v_add_u32 v30, 61440, v30
    v_exp_f32 v107, v107
    v_exp_f32 v108, v108
    v_exp_f32 v109, v109
    v_exp_f32 v110, v110
    v_exp_f32 v111, v111
    v_exp_f32 v112, v112
    v_exp_f32 v113, v113
    v_exp_f32 v114, v114
    v_smfmac_f32_32x32x32_bf16 v[62:77], v[44:47], v[102:109], v28
    s_waitcnt lgkmcnt(0)
    v_exp_f32 v115, v115
    v_exp_f32 v116, v116
    v_exp_f32 v117, v117
    v_mfma_f32_32x32x16_bf16 v[94:109], v[14:17], v[4:7], v[136:151]
    v_exp_f32 v118, v118
    v_exp_f32 v119, v119
    v_exp_f32 v120, v120
    v_exp_f32 v121, v121
    v_smfmac_f32_32x32x32_bf16 v[78:93], v[40:43], v[110:117], v28
    ds_read_b128 v[40:43], v30 offset:0
    v_exp_f32 v122, v122
    v_exp_f32 v123, v123
    v_exp_f32 v124, v124
    v_exp_f32 v125, v125
    v_exp_f32 v94, v94
    v_exp_f32 v95, v95
    v_smfmac_f32_32x32x32_bf16 v[78:93], v[44:47], v[118:125], v28
    ds_read_b128 v[44:47], v30 offset:640
    v_exp_f32 v96, v96
    v_exp_f32 v97, v97
    v_exp_f32 v98, v98
    v_mfma_f32_32x32x16_bf16 v[110:125], v[14:17], v[8:11], v[152:167]
    s_waitcnt lgkmcnt(1)
    ds_read2st64_b64 v[14:17], v29 offset0:242 offset1:243
    v_exp_f32 v99, v99
    v_exp_f32 v100, v100
    v_exp_f32 v101, v101
    v_exp_f32 v102, v102
    v_exp_f32 v103, v103
    v_smfmac_f32_32x32x32_bf16 v[62:77], v[40:43], v[94:101], v28
    s_waitcnt lgkmcnt(1)
    v_exp_f32 v104, v104
    v_exp_f32 v105, v105
    v_exp_f32 v106, v106
    v_mfma_f32_32x32x4_2b_bf16 v[136:167], v[18:19], v[12:13], 0 cbsz:1 abid:1
    v_exp_f32 v107, v107
    v_exp_f32 v108, v108
    v_exp_f32 v109, v109
    v_exp_f32 v110, v110
    v_exp_f32 v111, v111
    v_exp_f32 v112, v112
    v_exp_f32 v113, v113
    v_exp_f32 v114, v114
    v_smfmac_f32_32x32x32_bf16 v[62:77], v[44:47], v[102:109], v28
    s_waitcnt lgkmcnt(0)
    v_exp_f32 v115, v115
    v_exp_f32 v116, v116
    v_exp_f32 v117, v117
    v_mfma_f32_32x32x16_bf16 v[94:109], v[14:17], v[4:7], v[136:151]
    v_exp_f32 v118, v118
    v_exp_f32 v119, v119
    v_exp_f32 v120, v120
    v_exp_f32 v121, v121
    v_smfmac_f32_32x32x32_bf16 v[78:93], v[40:43], v[110:117], v28
    ds_read_b128 v[40:43], v30 offset:1280
    v_exp_f32 v122, v122
    v_exp_f32 v123, v123
    v_exp_f32 v124, v124
    v_exp_f32 v125, v125
    v_exp_f32 v94, v94
    v_exp_f32 v95, v95
    v_smfmac_f32_32x32x32_bf16 v[78:93], v[44:47], v[118:125], v28
    ds_read_b128 v[44:47], v30 offset:1920
    v_exp_f32 v96, v96
    v_exp_f32 v97, v97
    v_exp_f32 v98, v98
    v_mfma_f32_32x32x16_bf16 v[110:125], v[14:17], v[8:11], v[152:167]
    s_waitcnt lgkmcnt(1)
    ds_read2st64_b64 v[14:17], v29 offset0:244 offset1:245
    v_exp_f32 v99, v99
    v_exp_f32 v100, v100
    v_exp_f32 v101, v101
    v_exp_f32 v102, v102
    v_exp_f32 v103, v103
    v_smfmac_f32_32x32x32_bf16 v[62:77], v[40:43], v[94:101], v28
    s_waitcnt lgkmcnt(1)
    v_exp_f32 v104, v104
    v_exp_f32 v105, v105
    v_exp_f32 v106, v106
    v_mfma_f32_32x32x4_2b_bf16 v[136:167], v[20:21], v[12:13], 0 cbsz:1 abid:0
    v_exp_f32 v107, v107
    v_exp_f32 v108, v108
    v_exp_f32 v109, v109
    v_exp_f32 v110, v110
    v_exp_f32 v111, v111
    v_exp_f32 v112, v112
    v_exp_f32 v113, v113
    v_exp_f32 v114, v114
    v_smfmac_f32_32x32x32_bf16 v[62:77], v[44:47], v[102:109], v28
    s_waitcnt lgkmcnt(0)
    v_exp_f32 v115, v115
    v_exp_f32 v116, v116
    v_exp_f32 v117, v117
    v_mfma_f32_32x32x16_bf16 v[94:109], v[14:17], v[4:7], v[136:151]
    v_exp_f32 v118, v118
    v_exp_f32 v119, v119
    v_exp_f32 v120, v120
    v_exp_f32 v121, v121
    v_smfmac_f32_32x32x32_bf16 v[78:93], v[40:43], v[110:117], v28
    ds_read_b128 v[40:43], v30 offset:2560
    v_exp_f32 v122, v122
    v_exp_f32 v123, v123
    v_exp_f32 v124, v124
    v_exp_f32 v125, v125
    v_exp_f32 v94, v94
    v_exp_f32 v95, v95
    v_smfmac_f32_32x32x32_bf16 v[78:93], v[44:47], v[118:125], v28
    ds_read_b128 v[44:47], v30 offset:3200
    v_exp_f32 v96, v96
    v_exp_f32 v97, v97
    v_exp_f32 v98, v98
    v_mfma_f32_32x32x16_bf16 v[110:125], v[14:17], v[8:11], v[152:167]
    s_waitcnt lgkmcnt(1)
    ds_read2st64_b64 v[14:17], v29 offset0:246 offset1:247
    v_exp_f32 v99, v99
    v_exp_f32 v100, v100
    v_exp_f32 v101, v101
    v_exp_f32 v102, v102
    v_exp_f32 v103, v103
    v_smfmac_f32_32x32x32_bf16 v[62:77], v[40:43], v[94:101], v28
    s_waitcnt lgkmcnt(1)
    v_exp_f32 v104, v104
    v_exp_f32 v105, v105
    v_exp_f32 v106, v106
    v_mfma_f32_32x32x4_2b_bf16 v[136:167], v[20:21], v[12:13], 0 cbsz:1 abid:1
    v_add_u32 v29, 143360, v29
    v_exp_f32 v107, v107
    v_exp_f32 v108, v108
    v_exp_f32 v109, v109
    v_exp_f32 v110, v110
    v_exp_f32 v111, v111
    v_exp_f32 v112, v112
    v_exp_f32 v113, v113
    v_exp_f32 v114, v114
    v_smfmac_f32_32x32x32_bf16 v[62:77], v[44:47], v[102:109], v28
    s_waitcnt lgkmcnt(0)
    v_exp_f32 v115, v115
    v_exp_f32 v116, v116
    v_exp_f32 v117, v117
    v_mfma_f32_32x32x16_bf16 v[94:109], v[14:17], v[4:7], v[136:151]
    ds_read2st64_b64 v[18:21], v29 offset0:8 offset1:9
    v_exp_f32 v118, v118
    v_exp_f32 v119, v119
    v_exp_f32 v120, v120
    v_exp_f32 v121, v121
    v_smfmac_f32_32x32x32_bf16 v[78:93], v[40:43], v[110:117], v28
    ds_read_b128 v[40:43], v30 offset:3840
    v_exp_f32 v122, v122
    v_exp_f32 v123, v123
    v_exp_f32 v124, v124
    v_exp_f32 v125, v125
    v_exp_f32 v94, v94
    v_exp_f32 v95, v95
    v_smfmac_f32_32x32x32_bf16 v[78:93], v[44:47], v[118:125], v28
    ds_read_b128 v[44:47], v30 offset:4480
    v_exp_f32 v96, v96
    v_exp_f32 v97, v97
    v_exp_f32 v98, v98
    v_mfma_f32_32x32x16_bf16 v[110:125], v[14:17], v[8:11], v[152:167]
    s_waitcnt lgkmcnt(1)
    ds_read2st64_b64 v[14:17], v29 offset0:0 offset1:1
    v_exp_f32 v99, v99
    v_exp_f32 v100, v100
    v_exp_f32 v101, v101
    v_exp_f32 v102, v102
    v_exp_f32 v103, v103
    v_smfmac_f32_32x32x32_bf16 v[62:77], v[40:43], v[94:101], v28
    s_waitcnt lgkmcnt(1)
    v_exp_f32 v104, v104
    v_exp_f32 v105, v105
    v_exp_f32 v106, v106
    v_mfma_f32_32x32x4_2b_bf16 v[136:167], v[18:19], v[12:13], 0 cbsz:1 abid:0
    v_exp_f32 v107, v107
    v_exp_f32 v108, v108
    v_exp_f32 v109, v109
    v_exp_f32 v110, v110
    v_exp_f32 v111, v111
    v_exp_f32 v112, v112
    v_exp_f32 v113, v113
    v_exp_f32 v114, v114
    v_smfmac_f32_32x32x32_bf16 v[62:77], v[44:47], v[102:109], v28
    s_waitcnt lgkmcnt(0)
    v_exp_f32 v115, v115
    v_exp_f32 v116, v116
    v_exp_f32 v117, v117
    v_mfma_f32_32x32x16_bf16 v[94:109], v[14:17], v[4:7], v[136:151]
    s_mov_b64 exec, 1
    ds_write_b32 v1, v2
    s_mov_b64 exec, -1
    v_exp_f32 v118, v118
    v_exp_f32 v119, v119
    v_exp_f32 v120, v120
    v_exp_f32 v121, v121
    v_smfmac_f32_32x32x32_bf16 v[78:93], v[40:43], v[110:117], v28
    ds_read_b128 v[40:43], v30 offset:20480
    v_exp_f32 v122, v122
    v_exp_f32 v123, v123
    v_exp_f32 v124, v124
    v_exp_f32 v125, v125
    v_exp_f32 v94, v94
    v_exp_f32 v95, v95
    v_smfmac_f32_32x32x32_bf16 v[78:93], v[44:47], v[118:125], v28
    ds_read_b128 v[44:47], v30 offset:21120
    v_exp_f32 v96, v96
    v_exp_f32 v97, v97
    v_exp_f32 v98, v98
    v_mfma_f32_32x32x16_bf16 v[110:125], v[14:17], v[8:11], v[152:167]
    s_waitcnt lgkmcnt(1)
    ds_read2st64_b64 v[14:17], v29 offset0:2 offset1:3
    v_exp_f32 v99, v99
    v_exp_f32 v100, v100
    v_exp_f32 v101, v101
    v_exp_f32 v102, v102
    v_exp_f32 v103, v103
    v_smfmac_f32_32x32x32_bf16 v[62:77], v[40:43], v[94:101], v28
    s_waitcnt lgkmcnt(1)
    v_exp_f32 v104, v104
    v_exp_f32 v105, v105
    v_exp_f32 v106, v106
    v_mfma_f32_32x32x4_2b_bf16 v[136:167], v[18:19], v[12:13], 0 cbsz:1 abid:1
    v_exp_f32 v107, v107
    v_exp_f32 v108, v108
    v_exp_f32 v109, v109
    v_exp_f32 v110, v110
    v_exp_f32 v111, v111
    v_exp_f32 v112, v112
    v_exp_f32 v113, v113
    v_exp_f32 v114, v114
    v_smfmac_f32_32x32x32_bf16 v[62:77], v[44:47], v[102:109], v28
    s_waitcnt lgkmcnt(0)
    v_exp_f32 v115, v115
    v_exp_f32 v116, v116
    v_exp_f32 v117, v117
    v_mfma_f32_32x32x16_bf16 v[94:109], v[14:17], v[4:7], v[136:151]
    v_exp_f32 v118, v118
    v_exp_f32 v119, v119
    v_exp_f32 v120, v120
    v_exp_f32 v121, v121
    v_smfmac_f32_32x32x32_bf16 v[78:93], v[40:43], v[110:117], v28
    ds_read_b128 v[40:43], v30 offset:21760
    v_exp_f32 v122, v122
    v_exp_f32 v123, v123
    v_exp_f32 v124, v124
    v_exp_f32 v125, v125
    v_exp_f32 v94, v94
    v_exp_f32 v95, v95
    v_smfmac_f32_32x32x32_bf16 v[78:93], v[44:47], v[118:125], v28
    ds_read_b128 v[44:47], v30 offset:22400
    v_exp_f32 v96, v96
    v_exp_f32 v97, v97
    v_exp_f32 v98, v98
    v_mfma_f32_32x32x16_bf16 v[110:125], v[14:17], v[8:11], v[152:167]
    s_waitcnt lgkmcnt(1)
    ds_read2st64_b64 v[14:17], v29 offset0:4 offset1:5
    v_exp_f32 v99, v99
    v_exp_f32 v100, v100
    v_exp_f32 v101, v101
    v_exp_f32 v102, v102
    v_exp_f32 v103, v103
    v_smfmac_f32_32x32x32_bf16 v[62:77], v[40:43], v[94:101], v28
    s_waitcnt lgkmcnt(1)
    v_exp_f32 v104, v104
    v_exp_f32 v105, v105
    v_exp_f32 v106, v106
    v_mfma_f32_32x32x4_2b_bf16 v[136:167], v[20:21], v[12:13], 0 cbsz:1 abid:0
    v_exp_f32 v107, v107
    v_exp_f32 v108, v108
    v_exp_f32 v109, v109
    v_exp_f32 v110, v110
    v_exp_f32 v111, v111
    v_exp_f32 v112, v112
    v_exp_f32 v113, v113
    v_exp_f32 v114, v114
    v_smfmac_f32_32x32x32_bf16 v[62:77], v[44:47], v[102:109], v28
    s_waitcnt lgkmcnt(0)
    v_exp_f32 v115, v115
    v_exp_f32 v116, v116
    v_exp_f32 v117, v117
    v_mfma_f32_32x32x16_bf16 v[94:109], v[14:17], v[4:7], v[136:151]
    v_exp_f32 v118, v118
    v_exp_f32 v119, v119
    v_exp_f32 v120, v120
    v_exp_f32 v121, v121
    v_smfmac_f32_32x32x32_bf16 v[78:93], v[40:43], v[110:117], v28
    ds_read_b128 v[40:43], v30 offset:23040
    v_exp_f32 v122, v122
    v_exp_f32 v123, v123
    v_exp_f32 v124, v124
    v_exp_f32 v125, v125
    v_exp_f32 v94, v94
    v_exp_f32 v95, v95
    v_smfmac_f32_32x32x32_bf16 v[78:93], v[44:47], v[118:125], v28
    ds_read_b128 v[44:47], v30 offset:23680
    v_exp_f32 v96, v96
    v_exp_f32 v97, v97
    v_exp_f32 v98, v98
    v_mfma_f32_32x32x16_bf16 v[110:125], v[14:17], v[8:11], v[152:167]
    s_waitcnt lgkmcnt(1)
    ds_read2st64_b64 v[14:17], v29 offset0:6 offset1:7
    v_exp_f32 v99, v99
    v_exp_f32 v100, v100
    v_exp_f32 v101, v101
    v_exp_f32 v102, v102
    v_exp_f32 v103, v103
    v_smfmac_f32_32x32x32_bf16 v[62:77], v[40:43], v[94:101], v28
    s_waitcnt lgkmcnt(1)
    v_exp_f32 v104, v104
    v_exp_f32 v105, v105
    v_exp_f32 v106, v106
    v_mfma_f32_32x32x4_2b_bf16 v[136:167], v[20:21], v[12:13], 0 cbsz:1 abid:1
    v_exp_f32 v107, v107
    v_exp_f32 v108, v108
    v_exp_f32 v109, v109
    v_exp_f32 v110, v110
    v_exp_f32 v111, v111
    v_exp_f32 v112, v112
    v_exp_f32 v113, v113
    v_exp_f32 v114, v114
    v_smfmac_f32_32x32x32_bf16 v[62:77], v[44:47], v[102:109], v28
    s_waitcnt lgkmcnt(0)
    v_exp_f32 v115, v115
    v_exp_f32 v116, v116
    v_exp_f32 v117, v117
    v_mfma_f32_32x32x16_bf16 v[94:109], v[14:17], v[4:7], v[136:151]
    v_exp_f32 v118, v118
    v_exp_f32 v119, v119
    v_exp_f32 v120, v120
    v_exp_f32 v121, v121
    v_smfmac_f32_32x32x32_bf16 v[78:93], v[40:43], v[110:117], v28
    ds_read_b128 v[40:43], v30 offset:24320
    v_exp_f32 v122, v122
    v_exp_f32 v123, v123
    v_exp_f32 v124, v124
    v_exp_f32 v125, v125
    v_exp_f32 v94, v94
    v_exp_f32 v95, v95
    v_smfmac_f32_32x32x32_bf16 v[78:93], v[44:47], v[118:125], v28
    ds_read_b128 v[44:47], v30 offset:24960
    v_exp_f32 v96, v96
    v_exp_f32 v97, v97
    v_exp_f32 v98, v98
    v_mfma_f32_32x32x16_bf16 v[110:125], v[14:17], v[8:11], v[152:167]
    s_waitcnt lgkmcnt(1)
    v_exp_f32 v99, v99
    v_exp_f32 v100, v100
    v_exp_f32 v101, v101
    v_exp_f32 v102, v102
    v_exp_f32 v103, v103
    v_smfmac_f32_32x32x32_bf16 v[62:77], v[40:43], v[94:101], v28
    s_waitcnt lgkmcnt(0)
    v_exp_f32 v104, v104
    v_exp_f32 v105, v105
    v_exp_f32 v106, v106
    v_exp_f32 v107, v107
    v_exp_f32 v108, v108
    v_exp_f32 v109, v109
    v_exp_f32 v110, v110
    v_exp_f32 v111, v111
    v_smfmac_f32_32x32x32_bf16 v[62:77], v[44:47], v[102:109], v28
    s_cbranch_scc0 L_dp26
    s_setprio 1
    L_dp26:
    v_exp_f32 v112, v112
    v_exp_f32 v113, v113
    v_exp_f32 v114, v114
    v_exp_f32 v115, v115
    v_exp_f32 v116, v116
    v_exp_f32 v117, v117
    v_exp_f32 v118, v118
    v_exp_f32 v119, v119
    v_smfmac_f32_32x32x32_bf16 v[78:93], v[40:43], v[110:117], v28
    v_exp_f32 v120, v120
    v_exp_f32 v121, v121
    v_exp_f32 v122, v122
    v_exp_f32 v123, v123
    v_exp_f32 v124, v124
    v_exp_f32 v125, v125
    s_nop 1
    v_smfmac_f32_32x32x32_bf16 v[78:93], v[44:47], v[118:125], v28
    s_and_b32 s64, s3, 3
    s_mul_i32 s63, s64, 5120
    v_add_u32 v29, s63, v22
    s_lshl_b32 s63, s64, 2
    s_add_u32 s63, s63, 149424
    v_mov_b32 v30, s63
    s_cmp_ge_u32 s3, 4
    s_cbranch_scc1 L_at_late
    ds_write_b128 v29, v[62:65] offset:2560
    ds_write_b128 v29, v[66:69] offset:3584
    s_mov_b32 exec_hi, 0
    ds_write_b128 v29, v[70:73] offset:4608
    s_nop 1
    ds_write_b128 v29, v[86:89] offset:2048
    s_mov_b32 exec_hi, -1
    ds_write_b128 v29, v[78:81]
    ds_write_b128 v29, v[82:85] offset:1024
    v_mov_b32 v1, 1
    s_mov_b64 exec, 1
    ds_write_b32 v30, v1 offset:0
    s_mov_b64 exec, -1
    s_setprio 3
    s_and_b32 s48, s2, 7
    s_lshl_b32 s48, s48, 3
    s_bfe_u32 s49, s2, 0x30003
    s_add_u32 s48, s48, s49
    s_lshr_b32 s51, s2, 6
    s_mul_i32 s49, s51, 5
    s_cmp_eq_u32 s51, 3
    s_subb_u32 s49, s49, 0
    s_and_b32 s50, s3, 3
    s_add_u32 s49, s49, 4
    v_mov_b32 v60, 150384
    s_mov_b32 s71, 0x100000
    L_lp27:
    ds_read_b32 v61, v60 offset:0
    s_sub_u32 s71, s71, 1
    s_cbranch_scc1 L_le28
    s_waitcnt lgkmcnt(0)
    v_readfirstlane_b32 s69, v61
    s_cmp_ge_u32 s69, 1
    s_cbranch_scc1 L_le28
    s_sleep 4
    s_branch L_lp27
    L_le28:
    s_cmp_ge_u32 s2, 128
    s_cbranch_scc1 L_of_n5
    s_lshl_b32 s52, s49, 10
    s_add_u32 s52, s52, 16637952
    s_mul_i32 s54, s50, 147456
    s_add_u32 s52, s52, s54
    buffer_load_dwordx4 v[48:51], v22, s[12:15], s52 offen sc1
    s_add_u32 s52, s52, 18432
    buffer_load_dwordx4 v[52:55], v22, s[12:15], s52 offen sc1
    s_add_u32 s52, s52, 18432
    buffer_load_dwordx4 v[56:59], v22, s[12:15], s52 offen sc1
    s_add_u32 s52, s52, 18432
    buffer_load_dwordx4 v[126:129], v22, s[12:15], s52 offen sc1
    s_add_u32 s52, s52, 18432
    buffer_load_dwordx4 v[130:133], v22, s[12:15], s52 offen sc1
    s_add_u32 s52, s52, 18432
    buffer_load_dwordx4 v[24:27], v22, s[12:15], s52 offen sc1
    s_add_u32 s52, s52, 18432
    buffer_load_dwordx4 v[32:35], v22, s[12:15], s52 offen sc1
    s_add_u32 s52, s52, 18432
    buffer_load_dwordx4 v[36:39], v22, s[12:15], s52 offen sc1
    s_add_u32 s52, s52, 18432
    v_and_b32 v157, 3, v0
    v_bfe_u32 v159, v0, 2, 1
    v_lshl_or_b32 v157, v159, 4, v157
    v_bfe_u32 v159, v0, 3, 2
    v_lshl_or_b32 v157, v159, 2, v157
    v_lshlrev_b32 v157, 13, v157
    v_lshrrev_b32 v159, 5, v0
    v_lshl_or_b32 v157, v159, 4, v157
    v_and_b32 v158, 31, v0
    v_lshlrev_b32 v158, 3, v158
    s_lshl_b32 s52, s48, 8
    s_add_u32 s52, s52, 9543680
    s_lshl_b32 s51, s49, 18
    s_and_b32 s54, s48, 32
    s_lshl_b32 s54, s54, 6
    s_add_u32 s51, s51, s54
    s_and_b32 s54, s48, 30
    s_lshl_b32 s54, s54, 5
    s_add_u32 s51, s51, s54
    s_and_b32 s54, s48, 1
    s_lshl_b32 s54, s54, 10
    s_add_u32 s51, s51, s54
    s_add_u32 s51, s51, 11919360
    s_and_b32 s54, s50, 1
    s_lshl_b32 s54, s54, 5
    s_add_u32 s51, s51, s54
    s_lshr_b32 s54, s50, 1
    s_lshl_b32 s54, s54, 12
    s_add_u32 s51, s51, s54
    buffer_load_dword v156, v158, s[12:15], s52 offen sc1
    buffer_load_dwordx4 v[164:167], v157, s[12:15], s51 offen sc1
    s_lshl_b32 s52, s49, 10
    s_mul_i32 s54, s50, 18432
    s_add_u32 s51, s54, s52
    s_add_u32 s51, s51, 17227776
    buffer_load_dwordx4 v[160:163], v22, s[12:15], s51 offen sc1
    v_lshrrev_b32 v41, 5, v0
    v_and_b32 v42, 31, v0
    v_lshlrev_b32 v43, 9, v41
    v_lshl_add_u32 v43, v42, 2, v43
    s_lshl_b32 s52, s50, 10
    s_add_u32 s54, s52, 73728
    v_add_u32 v43, s54, v43
    v_lshrrev_b32 v41, 3, v0
    v_mul_u32_u24 v42, 1152, v41
    v_and_b32 v45, 7, v0
    v_lshl_add_u32 v42, v45, 3, v42
    v_and_b32 v45, 3, v0
    v_mul_u32_u24 v45, 1088, v45
    v_lshl_add_u32 v45, v41, 4, v45
    v_bfe_u32 v41, v0, 2, 1
    v_lshl_add_u32 v45, v41, 9, v45
    s_lshl_b32 s54, s50, 7
    s_add_u32 s54, s54, 77824
    v_add_u32 v45, s54, v45
    s_mul_i32 s52, s50, 4352
    s_add_u32 s52, s52, 77824
    v_add_u32 v44, s52, v22
    v_mov_b32 v47, 149104
    s_mul_i32 s53, s48, 36864
    s_lshl_b32 s56, s49, 6
    s_add_u32 s53, s53, s56
    s_mul_i32 s56, s50, 9216
    s_add_u32 s53, s53, s56
    v_bfe_u32 v158, v0, 1, 1
    v_lshlrev_b32 v158, 4, v158
    v_sub_u32 v158, 16, v158
    s_and_b32 s54, s50, 1
    s_waitcnt vmcnt(0)
    v_lshrrev_b32 v157, v158, v156
    s_lshl_b32 vcc_lo, 0x5, s54
    s_lshl_b32 vcc_hi, vcc_lo, 8
    v_cndmask_b32 v152, 0, v157, vcc
    s_lshl_b32 vcc_lo, 0x50, s54
    s_lshl_b32 vcc_hi, vcc_lo, 8
    v_cndmask_b32 v153, 0, v157, vcc
    s_lshl_b32 vcc_lo, 0x50000, s54
    s_lshl_b32 vcc_hi, vcc_lo, 8
    v_cndmask_b32 v154, 0, v157, vcc
    s_lshl_b32 vcc_lo, 0x500000, s54
    s_lshl_b32 vcc_hi, vcc_lo, 8
    v_cndmask_b32 v155, 0, v157, vcc
    s_nop 1
    v_mfma_f32_32x32x16_bf16 v[136:151], v[164:167], v[152:155], 0
    L_of_n5:
    s_mul_i32 s57, s48, 36864
    s_add_u32 s57, s57, 9560064
    s_lshl_b32 s58, s50, 13
    s_lshl_b32 s59, s50, 10
    s_add_u32 s59, s59, 32768
    s_add_u32 s60, s57, s58
    s_add_u32 s61, s60, 4096
    s_add_u32 s62, s57, s59
    s_add_u32 s58, s58, 40960
    s_add_u32 s59, s59, 40960
    v_add_u32 v4, s58, v22
    v_add_u32 v5, s59, v22
    s_lshl_b32 s52, s50, 2
    s_add_u32 s52, s52, 148784
    v_mov_b32 v6, s52
    s_lshl_b32 s55, s48, 5
    s_lshl_b32 s56, s50, 3
    s_add_u32 s55, s55, s56
    s_mul_i32 s55, s55, 128
    s_add_u32 s55, s55, 17389568
    v_and_b32 v8, 7, v0
    v_mul_u32_u24 v8, 128, v8
    v_bfe_u32 v9, v0, 2, 1
    v_mul_u32_u24 v9, 304, v9
    v_and_b32 v10, 7, v0
    v_lshl_add_u32 v9, v10, 2, v9
    v_add_u32 v9, 149744, v9
    s_mov_b32 s71, 0x100000
    L_pg29:
    ds_read_b32 v10, v9
    s_sub_u32 s71, s71, 1
    s_cbranch_scc1 L_pe30
    s_waitcnt lgkmcnt(0)
    v_cmp_eq_u32 vcc, 0, v10
    s_cbranch_vccz L_pe30
    s_sleep 6
    s_branch L_pg29
    L_pe30:
    s_mov_b64 s[16:17], -1
    s_mov_b64 s[18:19], -1
    s_mov_b64 s[20:21], -1
    s_mov_b64 s[22:23], -1
    s_mov_b64 s[24:25], -1
    s_mov_b64 s[26:27], -1
    s_mov_b64 s[28:29], -1
    s_mov_b64 s[30:31], -1
    s_mov_b64 s[32:33], -1
    s_mov_b64 exec, 0xff
    s_mov_b32 s71, 0x40000
    L_gp31:
    v_mov_b32 v9, 0
    buffer_atomic_or v9, v8, s[12:15], s55 offen sc0 sc1
    s_sub_u32 s71, s71, 1
    s_cbranch_scc1 L_ge32
    s_waitcnt vmcnt(0)
    v_xor_b32 v9, s70, v9
    v_cmp_ne_u32 vcc, 0, v9
    s_cbranch_vccz L_ge32
    s_sleep 3
    s_branch L_gp31
    L_ge32:
    s_mov_b32 s71, 0x40000
    s_setprio 3
    L_of_loop:
    s_mov_b64 exec, s[16:17]
    buffer_load_dwordx4 v[90:93], v22, s[12:15], s60 offen offset:0 sc1
    s_mov_b64 exec, s[18:19]
    buffer_load_dwordx4 v[94:97], v22, s[12:15], s60 offen offset:1024 sc1
    s_mov_b64 exec, s[20:21]
    buffer_load_dwordx4 v[98:101], v22, s[12:15], s60 offen offset:2048 sc1
    s_mov_b64 exec, s[22:23]
    buffer_load_dwordx4 v[102:105], v22, s[12:15], s60 offen offset:3072 sc1
    s_mov_b64 exec, s[24:25]
    buffer_load_dwordx4 v[106:109], v22, s[12:15], s61 offen offset:0 sc1
    s_mov_b64 exec, s[26:27]
    buffer_load_dwordx4 v[110:113], v22, s[12:15], s61 offen offset:1024 sc1
    s_mov_b64 exec, s[28:29]
    buffer_load_dwordx4 v[114:117], v22, s[12:15], s61 offen offset:2048 sc1
    s_mov_b64 exec, s[30:31]
    buffer_load_dwordx4 v[118:121], v22, s[12:15], s61 offen offset:3072 sc1
    s_mov_b64 exec, s[32:33]
    buffer_load_dwordx4 v[122:125], v22, s[12:15], s62 offen offset:0 sc1
    s_mov_b64 exec, -1
    s_mov_b64 s[34:35], 0
    s_waitcnt vmcnt(8)
    ds_write_b128 v4, v[90:93] offset:0
    v_max3_u32 v7, v90, v91, v92
    v_max_u32 v7, v7, v93
    v_cmp_eq_u32 s[16:17], -1, v7
    s_waitcnt vmcnt(7)
    ds_write_b128 v4, v[94:97] offset:1024
    v_max3_u32 v7, v94, v95, v96
    v_max_u32 v7, v7, v97
    v_cmp_eq_u32 s[18:19], -1, v7
    s_or_b64 s[34:35], s[34:35], s[16:17]
    s_waitcnt vmcnt(6)
    ds_write_b128 v4, v[98:101] offset:2048
    v_max3_u32 v7, v98, v99, v100
    v_max_u32 v7, v7, v101
    v_cmp_eq_u32 s[20:21], -1, v7
    s_or_b64 s[34:35], s[34:35], s[18:19]
    s_waitcnt vmcnt(5)
    ds_write_b128 v4, v[102:105] offset:3072
    v_max3_u32 v7, v102, v103, v104
    v_max_u32 v7, v7, v105
    v_cmp_eq_u32 s[22:23], -1, v7
    s_or_b64 s[34:35], s[34:35], s[20:21]
    s_waitcnt vmcnt(4)
    ds_write_b128 v4, v[106:109] offset:4096
    v_max3_u32 v7, v106, v107, v108
    v_max_u32 v7, v7, v109
    v_cmp_eq_u32 s[24:25], -1, v7
    s_or_b64 s[34:35], s[34:35], s[22:23]
    s_waitcnt vmcnt(3)
    ds_write_b128 v4, v[110:113] offset:5120
    v_max3_u32 v7, v110, v111, v112
    v_max_u32 v7, v7, v113
    v_cmp_eq_u32 s[26:27], -1, v7
    s_or_b64 s[34:35], s[34:35], s[24:25]
    s_waitcnt vmcnt(2)
    ds_write_b128 v4, v[114:117] offset:6144
    v_max3_u32 v7, v114, v115, v116
    v_max_u32 v7, v7, v117
    v_cmp_eq_u32 s[28:29], -1, v7
    s_or_b64 s[34:35], s[34:35], s[26:27]
    s_waitcnt vmcnt(1)
    ds_write_b128 v4, v[118:121] offset:7168
    v_max3_u32 v7, v118, v119, v120
    v_max_u32 v7, v7, v121
    v_cmp_eq_u32 s[30:31], -1, v7
    s_or_b64 s[34:35], s[34:35], s[28:29]
    s_waitcnt vmcnt(0)
    ds_write_b128 v5, v[122:125]
    v_max3_u32 v7, v122, v123, v124
    v_max_u32 v7, v7, v125
    v_cmp_eq_u32 s[32:33], -1, v7
    s_or_b64 s[34:35], s[34:35], s[30:31]
    s_sub_u32 s71, s71, 1
    s_cbranch_scc1 L_of_ok
    s_or_b64 s[34:35], s[34:35], s[32:33]
    s_cbranch_scc0 L_of_ok
    s_waitcnt lgkmcnt(0)
    s_branch L_of_loop
    L_of_ok:
    v_mov_b32 v7, 1
    s_mov_b64 exec, 1
    ds_write_b32 v6, v7 offset:0
    s_mov_b64 exec, -1
    s_cmp_ge_u32 s2, 128
    s_cbranch_scc1 L_end
    s_setprio 0
    ds_read2_b32 v[10:11], v43 offset0:0 offset1:32
    ds_read2_b32 v[12:13], v43 offset0:64 offset1:96
    v_mfma_f32_32x32x16_bf16 v[136:151], v[48:51], v[90:93], v[136:151]
    v_mfma_f32_32x32x16_bf16 v[136:151], v[52:55], v[94:97], v[136:151]
    v_mfma_f32_32x32x16_bf16 v[136:151], v[56:59], v[98:101], v[136:151]
    v_mfma_f32_32x32x16_bf16 v[136:151], v[126:129], v[102:105], v[136:151]
    v_mfma_f32_32x32x16_bf16 v[136:151], v[130:133], v[106:109], v[136:151]
    v_mfma_f32_32x32x16_bf16 v[136:151], v[24:27], v[110:113], v[136:151]
    v_mfma_f32_32x32x16_bf16 v[136:151], v[32:35], v[114:117], v[136:151]
    v_mfma_f32_32x32x16_bf16 v[136:151], v[36:39], v[118:121], v[136:151]
    s_waitcnt lgkmcnt(0)
    v_mfma_f32_32x32x16_bf16 v[136:151], v[160:163], v[10:13], v[136:151]
    s_setprio 3
    s_nop 10
    ds_write_b128 v44, v[136:139] offset:0
    ds_write_b128 v44, v[140:143] offset:1088
    ds_write_b128 v44, v[144:147] offset:2176
    ds_write_b128 v44, v[148:151] offset:3264
    v_mov_b32 v7, 1
    s_mov_b64 exec, 1
    ds_write_b32 v6, v7 offset:320
    s_mov_b64 exec, -1
    s_mov_b32 s8, s42
    s_mov_b32 s9, s43
    s_mov_b32 s10, 2359296
    s_mov_b32 s11, 0x00020000
    s_mov_b32 s71, 0x100000
    L_lp33:
    ds_read_b128 v[10:13], v47 offset:0
    s_sub_u32 s71, s71, 1
    s_cbranch_scc1 L_le34
    s_waitcnt lgkmcnt(0)
    v_min3_u32 v10, v10, v11, v12
    v_min_u32 v10, v10, v13
    s_nop 0
    v_readfirstlane_b32 s69, v10
    s_cmp_ge_u32 s69, 1
    s_cbranch_scc1 L_le34
    s_sleep 1
    s_branch L_lp33
    L_le34:
    ds_read_b128 v[94:97], v45 offset:0
    ds_read_b128 v[98:101], v45 offset:4352
    ds_read_b128 v[102:105], v45 offset:8704
    ds_read_b128 v[106:109], v45 offset:13056
    s_waitcnt lgkmcnt(2)
    v_add_f32 v94, v94, v98
    v_add_f32 v95, v95, v99
    v_add_f32 v96, v96, v100
    v_add_f32 v97, v97, v101
    s_waitcnt lgkmcnt(0)
    v_add_f32 v102, v102, v106
    v_add_f32 v103, v103, v107
    v_add_f32 v104, v104, v108
    v_add_f32 v105, v105, v109
    v_add_f32 v94, v94, v102
    v_add_f32 v95, v95, v103
    v_add_f32 v96, v96, v104
    v_add_f32 v97, v97, v105
    v_cvt_pk_bf16_f32 v94, v94, v95
    v_cvt_pk_bf16_f32 v95, v96, v97
    buffer_store_dwordx2 v[94:95], v42, s[8:11], s53 offen sc1
    s_branch L_end
    L_at_late:
    buffer_store_dword v24, v26, s[12:15], s58 offen sc1
    s_mov_b32 s71, 0x100000
    s_mov_b32 s61, 0x21800000
    s_mov_b32 s62, 0x53800000
    L_at_xw:
    ds_read_b32 v32, v30
    ds_read_b128 v[102:105], v29 offset:2048
    ds_read_b128 v[114:117], v29 offset:4608
    ds_read_b128 v[94:97], v29 offset:0
    ds_read_b128 v[98:101], v29 offset:1024
    ds_read_b128 v[106:109], v29 offset:2560
    ds_read_b128 v[110:113], v29 offset:3584
    s_sub_u32 s59, s100, 36864
    s_sub_u32 s60, s101, 36864
    s_sub_u32 s71, s71, 1
    s_cbranch_scc1 L_at_xok
    s_waitcnt lgkmcnt(6)
    v_readfirstlane_b32 s63, v32
    s_cmp_eq_u32 s63, 0
    s_cbranch_scc1 L_at_xw
    L_at_xok:
    s_waitcnt lgkmcnt(4)
    v_add_f32 v72, v72, v104
    v_add_f32 v88, v88, v116
    v_add_f32 v70, v70, v102
    v_add_f32 v71, v71, v103
    v_add_f32 v86, v86, v114
    v_add_f32 v87, v87, v115
    v_cmp_le_f32 vcc, s61, v72
    v_cmp_ge_f32 s[64:65], s62, v72
    v_cmp_le_f32 s[66:67], s61, v88
    v_cmp_ge_f32 s[68:69], s62, v88
    s_waitcnt lgkmcnt(0)
    v_add_f32 v62, v62, v94
    v_add_f32 v63, v63, v95
    v_add_f32 v64, v64, v96
    v_add_f32 v65, v65, v97
    v_add_f32 v66, v66, v98
    v_add_f32 v67, v67, v99
    v_add_f32 v68, v68, v100
    v_add_f32 v69, v69, v101
    v_add_f32 v78, v78, v106
    v_add_f32 v79, v79, v107
    v_add_f32 v80, v80, v108
    v_add_f32 v81, v81, v109
    v_add_f32 v82, v82, v110
    v_add_f32 v83, v83, v111
    v_add_f32 v84, v84, v112
    v_add_f32 v85, v85, v113
    s_and_b32 s64, s64, vcc_lo
    s_and_b32 s66, s66, s68
    s_and_b32 s64, s64, s66
    s_cmp_eq_u32 s64, -1
    s_cbranch_scc0 L_at_fallback
    L_at_fin:
    v_rcp_f32 v32, v72
    v_rcp_f32 v34, v88
    v_mul_f32 v32, v32, v31
    v_mul_f32 v34, v34, v25
    v_mov_b32 v33, v32
    v_mov_b32 v35, v34
    v_mul_f32 v70, v32, v70
    v_mul_f32 v71, v32, v71
    v_permlane32_swap_b32 v32, v33
    v_permlane32_swap_b32 v34, v35
    v_mul_f32 v62, v32, v62
    v_mul_f32 v63, v32, v63
    v_mul_f32 v64, v32, v64
    v_mul_f32 v65, v32, v65
    v_mul_f32 v66, v32, v66
    v_mul_f32 v67, v32, v67
    v_mul_f32 v68, v32, v68
    v_mul_f32 v69, v32, v69
    v_cvt_pk_bf16_f32 v62, v62, v63
    v_cvt_pk_bf16_f32 v63, v64, v65
    v_cvt_pk_bf16_f32 v64, v66, v67
    v_cvt_pk_bf16_f32 v65, v68, v69
    buffer_store_dwordx4 v[62:65], v22, s[12:15], s100 offen sc1
    v_mul_f32 v78, v34, v78
    v_mul_f32 v79, v34, v79
    v_mul_f32 v80, v34, v80
    v_mul_f32 v81, v34, v81
    v_mul_f32 v82, v34, v82
    v_mul_f32 v83, v34, v83
    v_mul_f32 v84, v34, v84
    v_mul_f32 v85, v34, v85
    v_cvt_pk_bf16_f32 v78, v78, v79
    v_cvt_pk_bf16_f32 v79, v80, v81
    v_cvt_pk_bf16_f32 v80, v82, v83
    v_cvt_pk_bf16_f32 v81, v84, v85
    buffer_store_dwordx4 v[78:81], v22, s[12:15], s59 offen sc1
    v_mul_f32 v86, v34, v86
    v_mul_f32 v87, v34, v87
    v_cvt_pk_bf16_f32 v70, v70, v71
    v_cvt_pk_bf16_f32 v86, v86, v87
    s_mov_b32 exec_hi, 0
    buffer_store_dword v70, v23, s[12:15], s101 offen sc1
    buffer_store_dword v86, v23, s[12:15], s60 offen sc1
    s_mov_b32 exec_lo, 3
    s_branch L_end
    L_at_fb:
    s_barrier
    s_branch L_at_fb_ret
L_at_fallback:
    v_and_b32 v33, 3, v0
    v_lshlrev_b32 v33, 4, v33
    v_bfe_u32 v32, v0, 2, 1
    v_lshl_or_b32 v33, v32, 7, v33
    v_bfe_u32 v32, v0, 3, 1
    v_lshl_or_b32 v33, v32, 6, v33
    v_bfe_u32 v32, v0, 4, 1
    v_lshl_or_b32 v33, v32, 3, v33
    v_lshrrev_b32 v30, 5, v0
    v_lshl_or_b32 v29, v30, 8, v33
    v_and_b32 v32, 31, v0
    s_mul_i32 s63, s96, 18
    v_add_u32 v34, s63, v32
    v_mul_u32_u24 v30, 9344, v30
    v_lshl_add_u32 v30, v34, 4, v30
    s_mov_b32 s69, 0
    v_mov_b32 v114, v12
    v_mov_b32 v115, v13
    s_mov_b32 exec_lo, 0
    v_mov_b32 v114, 0
    v_mov_b32 v115, 0
    s_mov_b32 exec_lo, -1
    v_mov_b32 v110, v4
    v_mov_b32 v111, v5
    v_mov_b32 v112, v6
    v_mov_b32 v113, v7
    v_mov_b32 v40, 0x3f803f80
    v_mov_b32 v41, 0x3f803f80
    v_mov_b32 v42, 0x3f803f80
    v_mov_b32 v43, 0x3f803f80
    v_mov_b32 v44, 0x3f803f80
    v_mov_b32 v45, 0x3f803f80
    v_mov_b32 v46, 0x3f803f80
    v_mov_b32 v47, 0x3f803f80
    L_fb_blk:
    v_mov_b32 v36, 0xff800000
    s_mov_b32 s67, 0
    v_mov_b32 v136, 0
    v_mov_b32 v137, 0
    v_mov_b32 v138, 0
    v_mov_b32 v139, 0
    v_mov_b32 v140, 0
    v_mov_b32 v141, 0
    v_mov_b32 v142, 0
    v_mov_b32 v143, 0
    v_mov_b32 v144, 0
    v_mov_b32 v145, 0
    v_mov_b32 v146, 0
    v_mov_b32 v147, 0
    v_mov_b32 v148, 0
    v_mov_b32 v149, 0
    v_mov_b32 v150, 0
    v_mov_b32 v151, 0
    L_fb_pass:
    s_add_u32 s63, s57, 36864
    s_add_u32 s64, s55, 36864
    s_mov_b32 s65, 4718592
    s_mov_b32 s66, 0
    L_fb_loop:
    s_add_u32 s68, s65, 18688
    buffer_load_dwordx2 v[14:15], v29, s[12:15], s63 offen sc1
    buffer_load_dwordx2 v[16:17], v29, s[12:15], s63 offen offset:512 sc1
    buffer_load_dwordx2 v[18:19], v33, s[12:15], s64 offen sc1
    s_mov_b32 exec_lo, 0x3ffff
    s_mov_b32 exec_hi, 0x3ffff
    buffer_load_dwordx4 v[40:43], v30, s[12:15], s65 offen sc1
    buffer_load_dwordx4 v[44:47], v30, s[12:15], s68 offen sc1
    s_mov_b64 exec, -1
    s_waitcnt vmcnt(0)
    v_mfma_f32_32x32x16_bf16 v[94:109], v[14:17], v[110:113], 0
    s_nop 10
    v_mfma_f32_32x32x8_bf16 v[94:109], v[18:19], v[114:115], v[94:109]
    s_add_u32 s63, s63, 73728
    s_add_u32 s64, s64, 73728
    s_add_u32 s65, s65, 37376
    s_add_u32 s66, s66, 1
    s_nop 15
    s_cmp_lg_u32 s67, 0
    s_cbranch_scc1 L_fb_p2
    v_max3_f32 v36, v36, v94, v95
    v_max3_f32 v36, v36, v96, v97
    v_max3_f32 v36, v36, v98, v99
    v_max3_f32 v36, v36, v100, v101
    v_max3_f32 v36, v36, v102, v103
    v_max3_f32 v36, v36, v104, v105
    v_max3_f32 v36, v36, v106, v107
    v_max3_f32 v36, v36, v108, v109
    s_cmp_lt_u32 s66, 64
    s_cbranch_scc1 L_fb_loop
    v_mov_b32 v37, v36
    s_nop 1
    v_permlane32_swap_b32 v36, v37
    s_mov_b32 s67, 1
    v_max_f32 v36, v36, v37
    s_branch L_fb_pass
    L_fb_p2:
    v_sub_f32 v94, v94, v36
    v_sub_f32 v95, v95, v36
    v_sub_f32 v96, v96, v36
    v_sub_f32 v97, v97, v36
    v_sub_f32 v98, v98, v36
    v_sub_f32 v99, v99, v36
    v_sub_f32 v100, v100, v36
    v_sub_f32 v101, v101, v36
    v_sub_f32 v102, v102, v36
    v_sub_f32 v103, v103, v36
    v_sub_f32 v104, v104, v36
    v_sub_f32 v105, v105, v36
    v_sub_f32 v106, v106, v36
    v_sub_f32 v107, v107, v36
    v_sub_f32 v108, v108, v36
    v_sub_f32 v109, v109, v36
    v_exp_f32 v94, v94
    v_exp_f32 v95, v95
    v_exp_f32 v96, v96
    v_exp_f32 v97, v97
    v_exp_f32 v98, v98
    v_exp_f32 v99, v99
    v_exp_f32 v100, v100
    v_exp_f32 v101, v101
    v_exp_f32 v102, v102
    v_exp_f32 v103, v103
    v_exp_f32 v104, v104
    v_exp_f32 v105, v105
    v_exp_f32 v106, v106
    v_exp_f32 v107, v107
    v_exp_f32 v108, v108
    v_exp_f32 v109, v109
    s_nop 2
    v_smfmac_f32_32x32x32_bf16 v[136:151], v[40:43], v[94:101], v28
    v_smfmac_f32_32x32x32_bf16 v[136:151], v[44:47], v[102:109], v28
    s_cmp_lt_u32 s66, 64
    s_cbranch_scc1 L_fb_loop
    s_nop 15
    s_cmp_lg_u32 s69, 0
    s_cbranch_scc1 L_fb_done
    s_mov_b32 s69, 1
    v_mov_b32 v114, 0
    v_mov_b32 v115, 0
    v_mov_b32 v62, v136
    v_mov_b32 v63, v137
    v_mov_b32 v64, v138
    v_mov_b32 v65, v139
    v_mov_b32 v66, v140
    v_mov_b32 v67, v141
    v_mov_b32 v68, v142
    v_mov_b32 v69, v143
    v_mov_b32 v70, v144
    v_mov_b32 v71, v145
    v_mov_b32 v72, v146
    v_mov_b32 v73, v147
    v_mov_b32 v110, v8
    v_mov_b32 v111, v9
    v_mov_b32 v112, v10
    v_mov_b32 v113, v11
    v_permlane32_swap_b32 v12, v114
    v_permlane32_swap_b32 v13, v115
    s_branch L_fb_blk
    L_fb_done:
    v_mov_b32 v78, v136
    v_mov_b32 v79, v137
    v_mov_b32 v80, v138
    v_mov_b32 v81, v139
    v_mov_b32 v82, v140
    v_mov_b32 v83, v141
    v_mov_b32 v84, v142
    v_mov_b32 v85, v143
    v_mov_b32 v86, v144
    v_mov_b32 v87, v145
    v_mov_b32 v88, v146
    v_mov_b32 v89, v147
    s_branch L_at_fin
L_util:
    v_mov_b32 v2, 0
    v_lshlrev_b32 v3, 2, v0
    v_add_u32 v3, 157696, v3
    ds_write_b32 v3, v2
    s_waitcnt lgkmcnt(0)
    s_mov_b32 s12, s46
    s_mov_b32 s13, s47
    s_mov_b32 s14, 17766528
    s_mov_b32 s15, 0x00020000
    s_add_u32 s100, s46, 17651712
    s_addc_u32 s101, s47, 0
    s_load_dword s70, s[100:101], 0
    s_waitcnt lgkmcnt(0)
    s_mul_i32 s70, s70, 0x9e3779b1
    s_add_u32 s70, s70, 0x7f4a7c15
L_kv:
    s_setprio 3
    s_and_b32 s96, s2, 7
    s_lshl_b32 s96, s96, 2
    s_lshr_b32 s97, s2, 6
    s_add_u32 s96, s96, s97
    s_bfe_u32 s97, s2, 0x30003
    s_and_b32 s50, s3, 1
    s_bfe_u32 s51, s3, 0x10001
    s_mul_i32 s52, s51, 10240
    v_mov_b32 v46, -1
    s_cmp_eq_u32 s50, 0
    s_cbranch_scc0 L_kv_v
    s_lshr_b32 s55, s96, 1
    s_mul_i32 s55, s55, 2304
    s_and_b32 s56, s96, 1
    s_mul_i32 s57, s56, 1280
    v_lshl_add_u32 v40, v0, 4, s57
    v_add_u32 v41, 72704, v40
    v_add_u32 v42, 145408, v40
    v_add_u32 v43, 218112, v40
    v_lshrrev_b32 v1, 4, v0
    v_mul_u32_u24 v1, 73728, v1
    v_and_b32 v2, 15, v0
    v_lshl_add_u32 v1, v2, 4, v1
    v_add_u32 v44, 1024, v1
    s_add_u32 s55, s55, 36864
    s_mul_i32 s53, s51, 2359296
    s_add_u32 s53, s53, s55
    s_mov_b32 s54, 294912
    s_lshl_b32 s56, s56, 10
    s_add_u32 s58, s55, s56
    s_add_u32 s59, s58, 1024
    s_lshr_b32 s58, s58, 12
    s_lshr_b32 s59, s59, 12
    s_branch L_kv_go
    L_kv_v:
    s_mul_i32 s55, s96, 18
    s_and_b32 s56, s2, 15
    s_mul_i32 s56, s56, 9344
    s_add_u32 s56, s56, 9216
    s_mul_i32 s53, s51, 1196032
    s_add_u32 s53, s53, 4718592
    v_mul_u32_u24 v1, 149504, v0
    v_add_u32 v46, s56, v1
    v_mov_b32 v48, 0x3f803f80
    v_mov_b32 v49, v48
    v_mov_b32 v50, v48
    v_mov_b32 v51, v48
    v_mov_b32 v10, s56
    v_add_u32 v1, 0, v0
    v_mul_u32_u24 v2, 3277, v1
    v_lshrrev_b32 v2, 16, v2
    v_mul_u32_u24 v3, 20, v2
    v_sub_u32 v1, v1, v3
    v_cmp_gt_u32 vcc, 18, v1
    v_add_u32 v1, s55, v1
    v_mul_u32_u24 v2, 9344, v2
    v_lshl_add_u32 v1, v1, 4, v2
    v_cndmask_b32 v40, v10, v1, vcc
    v_add_u32 v1, 64, v0
    v_mul_u32_u24 v2, 3277, v1
    v_lshrrev_b32 v2, 16, v2
    v_mul_u32_u24 v3, 20, v2
    v_sub_u32 v1, v1, v3
    v_cmp_gt_u32 vcc, 18, v1
    v_add_u32 v1, s55, v1
    v_mul_u32_u24 v2, 9344, v2
    v_lshl_add_u32 v1, v1, 4, v2
    v_cndmask_b32 v41, v10, v1, vcc
    v_subrev_u32 v41, 1024, v41
    v_add_u32 v1, 128, v0
    v_mul_u32_u24 v2, 3277, v1
    v_lshrrev_b32 v2, 16, v2
    v_mul_u32_u24 v3, 20, v2
    v_sub_u32 v1, v1, v3
    v_cmp_gt_u32 vcc, 18, v1
    v_add_u32 v1, s55, v1
    v_mul_u32_u24 v2, 9344, v2
    v_lshl_add_u32 v1, v1, 4, v2
    v_cndmask_b32 v42, v10, v1, vcc
    v_subrev_u32 v42, 2048, v42
    v_add_u32 v1, 192, v0
    v_mul_u32_u24 v2, 3277, v1
    v_lshrrev_b32 v2, 16, v2
    v_mul_u32_u24 v3, 20, v2
    v_sub_u32 v1, v1, v3
    v_cmp_gt_u32 vcc, 18, v1
    v_add_u32 v1, s55, v1
    v_mul_u32_u24 v2, 9344, v2
    v_lshl_add_u32 v1, v1, 4, v2
    v_cndmask_b32 v43, v10, v1, vcc
    v_subrev_u32 v43, 3072, v43
    v_add_u32 v1, 256, v0
    v_mul_u32_u24 v2, 3277, v1
    v_lshrrev_b32 v2, 16, v2
    v_mul_u32_u24 v3, 20, v2
    v_sub_u32 v1, v1, v3
    v_cmp_gt_u32 vcc, 18, v1
    v_add_u32 v1, s55, v1
    v_mul_u32_u24 v2, 9344, v2
    v_lshl_add_u32 v1, v1, 4, v2
    v_cndmask_b32 v44, v10, v1, vcc
    s_mov_b32 s54, 149504
    s_add_u32 s52, s52, 5120
    s_lshr_b32 s58, s55, 6
    s_add_u32 s59, s55, 17
    s_lshr_b32 s59, s59, 6
    s_add_u32 s58, s58, 18
    s_add_u32 s59, s59, 18
    L_kv_go:
    s_sub_u32 s59, s59, s58
    s_lshl_b32 s59, s59, 5
    v_bfe_u32 v1, v0, 4, 1
    v_mul_u32_u24 v1, s59, v1
    v_and_b32 v2, 15, v0
    v_add_u32 v1, v1, v2
    v_mul_u32_u24 v45, 128, v1
    s_lshl_b32 s58, s58, 5
    s_lshl_b32 s59, s51, 4
    s_add_u32 s58, s58, s59
    s_mul_i32 s58, s58, 128
    s_add_u32 s58, s58, 17651840
    s_cmp_ge_u32 s2, 224
    s_cbranch_scc1 L_kv_run
    s_cmp_lt_u32 s3, 10
    s_cbranch_scc1 L_kv_run
    s_cmp_eq_u32 s3, 10
    s_cbranch_scc1 L_ucopy
    s_barrier
    s_barrier
    s_barrier
    s_barrier
    L_ucopy:
    s_setprio 3
    s_lshr_b32 s60, s99, 6
    s_mul_i32 s60, s60, 4096
    s_add_u32 s60, s60, 17301504
    v_and_b32 v1, 31, v0
    v_mul_u32_u24 v1, 128, v1
    v_lshlrev_b32 v2, 2, v0
    s_and_b32 s61, s3, 1
    s_add_u32 s62, s99, s61
    s_mul_i32 s62, s62, 4224
    s_add_u32 s62, s62, 7110656
    s_mul_i32 s63, s61, 17152
    s_add_u32 s63, s63, 98304
    s_lshl_b32 s64, s61, 2
    s_add_u32 s64, s64, 157696
    v_mov_b32 v3, s64
    v_mov_b32 v9, 0
    v_add_u32 v10, s63, v2
    v_add_u32 v11, 124, v10
    v_add_u32 v12, 4408, v10
    v_add_u32 v13, 8692, v10
    v_add_u32 v14, 12976, v10
    s_barrier
    s_barrier
    s_barrier
    buffer_load_dword v4, v1, s[12:15], s60 offen sc1
    s_mov_b32 s66, 1
    s_barrier
    s_waitcnt vmcnt(0)
    v_cmp_ne_u32 vcc, s70, v4
    s_cbranch_vccz L_uc_set
    s_barrier
    s_mov_b32 s66, 0
    s_mov_b32 s71, 0x40000
    L_gp35:
    buffer_load_dword v4, v1, s[12:15], s60 offen sc1
    s_sub_u32 s71, s71, 1
    s_cbranch_scc1 L_ge36
    s_waitcnt vmcnt(0)
    v_xor_b32 v4, s70, v4
    v_cmp_ne_u32 vcc, 0, v4
    s_cbranch_vccz L_ge36
    s_sleep 2
    s_branch L_gp35
    L_ge36:
    L_uc_set:
    buffer_load_dword v16, v2, s[12:15], s62 offen offset:0 sc1
    buffer_load_dword v17, v2, s[12:15], s62 offen offset:256 sc1
    buffer_load_dword v18, v2, s[12:15], s62 offen offset:512 sc1
    buffer_load_dword v19, v2, s[12:15], s62 offen offset:768 sc1
    buffer_load_dword v20, v2, s[12:15], s62 offen offset:1024 sc1
    buffer_load_dword v21, v2, s[12:15], s62 offen offset:1280 sc1
    buffer_load_dword v22, v2, s[12:15], s62 offen offset:1536 sc1
    buffer_load_dword v23, v2, s[12:15], s62 offen offset:1792 sc1
    buffer_load_dword v24, v2, s[12:15], s62 offen offset:2048 sc1
    buffer_load_dword v25, v2, s[12:15], s62 offen offset:2304 sc1
    buffer_load_dword v26, v2, s[12:15], s62 offen offset:2560 sc1
    buffer_load_dword v27, v2, s[12:15], s62 offen offset:2816 sc1
    buffer_load_dword v28, v2, s[12:15], s62 offen offset:3072 sc1
    buffer_load_dword v29, v2, s[12:15], s62 offen offset:3328 sc1
    buffer_load_dword v30, v2, s[12:15], s62 offen offset:3584 sc1
    buffer_load_dword v31, v2, s[12:15], s62 offen offset:3840 sc1
    s_cmp_eq_u32 s66, 0
    s_cbranch_scc1 L_uc_nb
    s_barrier
    L_uc_nb:
    s_setprio 0
    s_mov_b64 exec, 0x7fffffff
    ds_write_b32 v10, v9 offset:0
    ds_write_b32 v10, v9 offset:4288
    ds_write_b32 v10, v9 offset:8576
    ds_write_b32 v10, v9 offset:12864
    s_mov_b64 exec, -1
    s_waitcnt vmcnt(14)
    ds_write2st64_b32 v11, v16, v17 offset0:0 offset1:1
    ds_write2st64_b32 v12, v16, v17 offset0:0 offset1:1
    ds_write2st64_b32 v13, v16, v17 offset0:0 offset1:1
    ds_write2st64_b32 v14, v16, v17 offset0:0 offset1:1
    s_waitcnt vmcnt(12)
    ds_write2st64_b32 v11, v18, v19 offset0:2 offset1:3
    ds_write2st64_b32 v12, v18, v19 offset0:2 offset1:3
    ds_write2st64_b32 v13, v18, v19 offset0:2 offset1:3
    ds_write2st64_b32 v14, v18, v19 offset0:2 offset1:3
    s_waitcnt vmcnt(10)
    ds_write2st64_b32 v11, v20, v21 offset0:4 offset1:5
    ds_write2st64_b32 v12, v20, v21 offset0:4 offset1:5
    ds_write2st64_b32 v13, v20, v21 offset0:4 offset1:5
    ds_write2st64_b32 v14, v20, v21 offset0:4 offset1:5
    s_waitcnt vmcnt(8)
    ds_write2st64_b32 v11, v22, v23 offset0:6 offset1:7
    ds_write2st64_b32 v12, v22, v23 offset0:6 offset1:7
    ds_write2st64_b32 v13, v22, v23 offset0:6 offset1:7
    ds_write2st64_b32 v14, v22, v23 offset0:6 offset1:7
    s_waitcnt vmcnt(6)
    ds_write2st64_b32 v11, v24, v25 offset0:8 offset1:9
    ds_write2st64_b32 v12, v24, v25 offset0:8 offset1:9
    ds_write2st64_b32 v13, v24, v25 offset0:8 offset1:9
    ds_write2st64_b32 v14, v24, v25 offset0:8 offset1:9
    s_waitcnt vmcnt(4)
    ds_write2st64_b32 v11, v26, v27 offset0:10 offset1:11
    ds_write2st64_b32 v12, v26, v27 offset0:10 offset1:11
    ds_write2st64_b32 v13, v26, v27 offset0:10 offset1:11
    ds_write2st64_b32 v14, v26, v27 offset0:10 offset1:11
    s_waitcnt vmcnt(2)
    ds_write2st64_b32 v11, v28, v29 offset0:12 offset1:13
    ds_write2st64_b32 v12, v28, v29 offset0:12 offset1:13
    ds_write2st64_b32 v13, v28, v29 offset0:12 offset1:13
    ds_write2st64_b32 v14, v28, v29 offset0:12 offset1:13
    s_waitcnt vmcnt(0)
    ds_write2st64_b32 v11, v30, v31 offset0:14 offset1:15
    ds_write2st64_b32 v12, v30, v31 offset0:14 offset1:15
    ds_write2st64_b32 v13, v30, v31 offset0:14 offset1:15
    ds_write2st64_b32 v14, v30, v31 offset0:14 offset1:15
    v_mov_b32 v4, 4
    s_mov_b64 exec, 1
    ds_write_b32 v3, v4 offset:16
    s_mov_b64 exec, -1
    s_setprio 3
    L_kv_run:
    v_mov_b32 v3, 157696
    s_bitcmp0_b32 s3, 0
    s_cbranch_scc1 L_kv_no1
    s_mov_b64 exec, 0xff
    buffer_store_dwordx4 v[48:51], v46, s[12:15], s53 offen sc1
    s_mov_b64 exec, -1
    L_kv_no1:
    s_cmp_lt_u32 s2, 224
    s_cbranch_scc1 L_kv_g
    s_mov_b32 s71, 0x100000
    L_lp37:
    ds_read_b128 v[12:15], v3 offset:96
    s_sub_u32 s71, s71, 1
    s_cbranch_scc1 L_le38
    s_waitcnt lgkmcnt(0)
    v_min3_u32 v12, v12, v13, v14
    v_min_u32 v12, v12, v15
    s_nop 0
    v_readfirstlane_b32 s69, v12
    s_cmp_ge_u32 s69, 1
    s_cbranch_scc1 L_le38
    s_sleep 4
    s_branch L_lp37
    L_le38:
    s_branch L_kv_g1
    L_kv_g:
    s_mov_b32 s71, 0x100000
    L_lp39:
    ds_read_b32 v12, v3 offset:0
    s_sub_u32 s71, s71, 1
    s_cbranch_scc1 L_le40
    s_waitcnt lgkmcnt(0)
    v_readfirstlane_b32 s69, v12
    s_cmp_ge_u32 s69, 4
    s_cbranch_scc1 L_le40
    s_sleep 2
    s_branch L_lp39
    L_le40:
    L_kv_g1:
    s_mov_b32 s59, 0
    s_mov_b32 exec_lo, 0xf000f
    s_mov_b32 exec_hi, 0
    s_mov_b32 s71, 0x40000
    L_gp41:
    buffer_load_dword v12, v45, s[12:15], s58 offen sc1
    s_sub_u32 s71, s71, 1
    s_cbranch_scc1 L_ge42
    s_waitcnt vmcnt(0)
    v_xor_b32 v12, s70, v12
    v_cmp_ne_u32 vcc, 0, v12
    s_cbranch_vccz L_ge42
    s_sleep 2
    s_branch L_gp41
    L_ge42:
    s_mov_b64 exec, -1
    s_mov_b32 s66, 0
L_kv_loop:
    s_mov_b32 m0, s52
    s_add_u32 s66, s66, 1
    buffer_load_dwordx4 v40, s[12:15], s53 offen offset:0 sc1 lds
    buffer_load_dwordx4 v41, s[12:15], s53 offen offset:1024 sc1 lds
    buffer_load_dwordx4 v42, s[12:15], s53 offen offset:2048 sc1 lds
    buffer_load_dwordx4 v43, s[12:15], s53 offen offset:3072 sc1 lds
    s_add_u32 m0, s52, 4096
    s_add_u32 s52, s52, 20480
    buffer_load_dwordx4 v44, s[12:15], s53 offen sc1 lds
    s_add_u32 s53, s53, s54
    s_cmp_eq_u32 s66, 4
    s_cselect_b32 s60, s59, 0
    s_sub_u32 s53, s53, s60
    s_cmp_lg_u32 s66, 2
    s_cbranch_scc1 L_kv_nb
    buffer_load_dword v12, v45, s[12:15], s58 offen sc1
    s_waitcnt vmcnt(6)
    s_barrier
    s_waitcnt vmcnt(0)
    v_cmp_ne_u32 vcc, s70, v12
    s_barrier
    s_cbranch_vccz L_kv_nb
    s_mov_b32 s71, 0x40000
    L_gp43:
    buffer_load_dword v12, v45, s[12:15], s58 offen sc1
    s_sub_u32 s71, s71, 1
    s_cbranch_scc1 L_ge44
    s_waitcnt vmcnt(0)
    v_xor_b32 v12, s70, v12
    v_cmp_ne_u32 vcc, 0, v12
    s_cbranch_vccz L_ge44
    s_sleep 4
    s_branch L_gp43
    L_ge44:
    L_kv_nb:
    s_cmp_lt_u32 s66, 8
    s_cbranch_scc1 L_kv_loop
    s_waitcnt vmcnt(20)
    s_barrier
    s_cmp_lg_u32 s3, 10
    s_cbranch_scc1 L_kv_ns
    s_mul_i32 s58, s97, 294912
    s_add_u32 s58, s58, 9560064
    s_lshl_b32 s59, s96, 7
    s_add_u32 s59, s59, s58
    s_add_u32 s59, s59, 32768
    s_lshl_b32 s60, s96, 10
    s_add_u32 s58, s58, s60
    v_lshlrev_b32 v1, 4, v0
    v_lshrrev_b32 v2, 3, v0
    v_mul_u32_u24 v2, 36736, v2
    v_add_u32 v2, v2, v1
    v_mov_b32 v16, -1
    v_mov_b32 v17, -1
    v_mov_b32 v18, -1
    v_mov_b32 v19, -1
    buffer_store_dwordx4 v[16:19], v2, s[12:15], s59 offen sc1
    buffer_store_dwordx4 v[16:19], v1, s[12:15], s58 offen sc1
    s_add_u32 s58, s58, 36864
    buffer_store_dwordx4 v[16:19], v1, s[12:15], s58 offen sc1
    s_add_u32 s58, s58, 36864
    buffer_store_dwordx4 v[16:19], v1, s[12:15], s58 offen sc1
    s_add_u32 s58, s58, 36864
    buffer_store_dwordx4 v[16:19], v1, s[12:15], s58 offen sc1
    s_add_u32 s58, s58, 36864
    buffer_store_dwordx4 v[16:19], v1, s[12:15], s58 offen sc1
    s_add_u32 s58, s58, 36864
    buffer_store_dwordx4 v[16:19], v1, s[12:15], s58 offen sc1
    s_add_u32 s58, s58, 36864
    buffer_store_dwordx4 v[16:19], v1, s[12:15], s58 offen sc1
    s_add_u32 s58, s58, 36864
    buffer_store_dwordx4 v[16:19], v1, s[12:15], s58 offen sc1
    s_add_u32 s58, s58, 36864
    L_kv_ns:
    s_waitcnt vmcnt(0)
    s_cmp_lg_u32 s3, 11
    s_cbranch_scc1 L_kv_nw
    s_cmp_ge_u32 s2, 144
    s_cbranch_scc1 L_kv_nw
    s_mov_b32 s4, s38
    s_mov_b32 s5, s39
    s_mov_b32 s6, 663552
    s_mov_b32 s7, 0x00020000
    s_and_b32 s50, s2, 7
    s_lshr_b32 s51, s2, 3
    s_mul_i32 s52, s50, 82944
    s_lshl_b32 s53, s51, 6
    s_add_u32 s52, s52, s53
    v_and_b32 v1, 3, v0
    v_bfe_u32 v2, v0, 2, 1
    v_lshl_or_b32 v1, v2, 4, v1
    v_bfe_u32 v2, v0, 3, 2
    v_lshl_or_b32 v1, v2, 2, v1
    v_lshlrev_b32 v1, 1, v1
    v_lshrrev_b32 v2, 5, v0
    v_mul_u32_u24 v2, 4608, v2
    v_add_u32 v2, v2, v1
    s_add_u32 s53, s52, 0
    buffer_load_ushort v20, v2, s[4:7], s53 offen offset:0
    buffer_load_ushort v21, v2, s[4:7], s53 offen offset:1152
    buffer_load_ushort v22, v2, s[4:7], s53 offen offset:2304
    buffer_load_ushort v23, v2, s[4:7], s53 offen offset:3456
    s_add_u32 s53, s52, 9216
    buffer_load_ushort v24, v2, s[4:7], s53 offen offset:0
    buffer_load_ushort v25, v2, s[4:7], s53 offen offset:1152
    buffer_load_ushort v26, v2, s[4:7], s53 offen offset:2304
    buffer_load_ushort v27, v2, s[4:7], s53 offen offset:3456
    s_add_u32 s53, s52, 18432
    buffer_load_ushort v52, v1, s[4:7], s53 offen offset:0
    buffer_load_ushort v53, v1, s[4:7], s53 offen offset:1152
    s_add_u32 s53, s52, 20736
    buffer_load_ushort v28, v2, s[4:7], s53 offen offset:0
    buffer_load_ushort v29, v2, s[4:7], s53 offen offset:1152
    buffer_load_ushort v30, v2, s[4:7], s53 offen offset:2304
    buffer_load_ushort v31, v2, s[4:7], s53 offen offset:3456
    s_add_u32 s53, s52, 29952
    buffer_load_ushort v32, v2, s[4:7], s53 offen offset:0
    buffer_load_ushort v33, v2, s[4:7], s53 offen offset:1152
    buffer_load_ushort v34, v2, s[4:7], s53 offen offset:2304
    buffer_load_ushort v35, v2, s[4:7], s53 offen offset:3456
    s_add_u32 s53, s52, 39168
    buffer_load_ushort v54, v1, s[4:7], s53 offen offset:0
    buffer_load_ushort v55, v1, s[4:7], s53 offen offset:1152
    s_add_u32 s53, s52, 41472
    buffer_load_ushort v36, v2, s[4:7], s53 offen offset:0
    buffer_load_ushort v37, v2, s[4:7], s53 offen offset:1152
    buffer_load_ushort v38, v2, s[4:7], s53 offen offset:2304
    buffer_load_ushort v39, v2, s[4:7], s53 offen offset:3456
    s_add_u32 s53, s52, 50688
    buffer_load_ushort v40, v2, s[4:7], s53 offen offset:0
    buffer_load_ushort v41, v2, s[4:7], s53 offen offset:1152
    buffer_load_ushort v42, v2, s[4:7], s53 offen offset:2304
    buffer_load_ushort v43, v2, s[4:7], s53 offen offset:3456
    s_add_u32 s53, s52, 59904
    buffer_load_ushort v56, v1, s[4:7], s53 offen offset:0
    buffer_load_ushort v57, v1, s[4:7], s53 offen offset:1152
    s_add_u32 s53, s52, 62208
    buffer_load_ushort v44, v2, s[4:7], s53 offen offset:0
    buffer_load_ushort v45, v2, s[4:7], s53 offen offset:1152
    buffer_load_ushort v46, v2, s[4:7], s53 offen offset:2304
    buffer_load_ushort v47, v2, s[4:7], s53 offen offset:3456
    s_add_u32 s53, s52, 71424
    buffer_load_ushort v48, v2, s[4:7], s53 offen offset:0
    buffer_load_ushort v49, v2, s[4:7], s53 offen offset:1152
    buffer_load_ushort v50, v2, s[4:7], s53 offen offset:2304
    buffer_load_ushort v51, v2, s[4:7], s53 offen offset:3456
    s_add_u32 s53, s52, 80640
    buffer_load_ushort v58, v1, s[4:7], s53 offen offset:0
    buffer_load_ushort v59, v1, s[4:7], s53 offen offset:1152
    v_lshlrev_b32 v2, 4, v0
    s_mul_i32 s52, s50, 73728
    s_lshl_b32 s53, s51, 10
    s_add_u32 s53, s53, 16637952
    s_add_u32 s52, s52, s53
    s_lshr_b32 s54, s50, 1
    s_add_u32 s54, s54, 32
    s_mul_i32 s54, s54, 18432
    s_add_u32 s54, s54, s53
    s_and_b32 s55, s50, 1
    s_lshl_b32 s55, s55, 9
    s_add_u32 s54, s54, s55
    s_waitcnt vmcnt(0)
    v_lshl_or_b32 v20, v21, 16, v20
    v_lshl_or_b32 v21, v23, 16, v22
    v_lshl_or_b32 v22, v25, 16, v24
    v_lshl_or_b32 v23, v27, 16, v26
    v_lshl_or_b32 v24, v29, 16, v28
    v_lshl_or_b32 v25, v31, 16, v30
    v_lshl_or_b32 v26, v33, 16, v32
    v_lshl_or_b32 v27, v35, 16, v34
    v_lshl_or_b32 v28, v37, 16, v36
    v_lshl_or_b32 v29, v39, 16, v38
    v_lshl_or_b32 v30, v41, 16, v40
    v_lshl_or_b32 v31, v43, 16, v42
    v_lshl_or_b32 v32, v45, 16, v44
    v_lshl_or_b32 v33, v47, 16, v46
    v_lshl_or_b32 v34, v49, 16, v48
    v_lshl_or_b32 v35, v51, 16, v50
    v_lshl_or_b32 v36, v53, 16, v52
    v_lshl_or_b32 v37, v55, 16, v54
    v_lshl_or_b32 v38, v57, 16, v56
    v_lshl_or_b32 v39, v59, 16, v58
    buffer_store_dwordx4 v[20:23], v2, s[12:15], s52 offen sc1
    s_add_u32 s52, s52, 18432
    buffer_store_dwordx4 v[24:27], v2, s[12:15], s52 offen sc1
    s_add_u32 s52, s52, 18432
    buffer_store_dwordx4 v[28:31], v2, s[12:15], s52 offen sc1
    s_add_u32 s52, s52, 18432
    buffer_store_dwordx4 v[32:35], v2, s[12:15], s52 offen sc1
    s_mov_b32 exec_hi, 0
    buffer_store_dwordx4 v[36:39], v2, s[12:15], s54 offen sc1
    s_mov_b32 exec_hi, -1
    s_mul_i32 s54, s2, 128
    s_add_u32 s54, s54, 17371136
    s_waitcnt vmcnt(0)
    v_mov_b32 v4, s70
    v_lshlrev_b32 v5, 2, v0
    s_mov_b32 exec_hi, 0
    buffer_store_dword v4, v5, s[12:15], s54 offen sc1
    s_mov_b64 exec, -1
    L_kv_nw:
    s_cmp_lg_u32 s3, 9
    s_cbranch_scc1 L_kv_nz
    v_mul_u32_u24 v1, 320, v0
    v_add_u32 v1, 148784, v1
    v_mov_b32 v16, 0
    v_mov_b32 v17, 0
    v_mov_b32 v18, 0
    v_mov_b32 v19, 0
    s_mov_b64 exec, 63
    ds_write_b128 v1, v[16:19]
    s_mov_b64 exec, -1
    s_waitcnt lgkmcnt(0)
    L_kv_nz:
    s_barrier
    s_cmp_lg_u32 s3, 8
    s_cbranch_scc1 L_kv_nf
    s_mul_i32 s58, s2, 128
    s_add_u32 s58, s58, 17338368
    v_mov_b32 v12, s70
    v_lshlrev_b32 v13, 2, v0
    s_mov_b32 exec_hi, 0
    buffer_store_dword v12, v13, s[12:15], s58 offen sc1
    s_mov_b64 exec, -1
    L_kv_nf:
    s_cmp_lg_u32 s3, 8
    s_cbranch_scc1 L_op_n5
    s_and_b32 s48, s2, 7
    s_lshl_b32 s48, s48, 3
    s_bfe_u32 s49, s2, 0x30003
    s_add_u32 s48, s48, s49
    s_lshr_b32 s51, s2, 6
    s_mul_i32 s49, s51, 5
    s_cmp_eq_u32 s51, 3
    s_subb_u32 s49, s49, 0
    s_and_b32 s50, s3, 3
    s_add_u32 s49, s49, 4
    s_min_u32 s49, s49, 17
    s_lshl_b32 s52, s49, 4
    s_lshl_b32 s54, s49, 3
    s_lshl1_add_u32 s51, s49, 196
    s_cmp_lt_u32 s49, 14
    s_cselect_b32 s52, s52, s51
    s_cselect_b32 s51, 14, 6
    v_and_b32 v4, s51, v0
    s_cselect_b32 s51, 0, 2
    v_lshlrev_b32 v4, s51, v4
    v_and_or_b32 v4, v0, 1, v4
    v_add_u32 v4, s52, v4
    s_add_u32 s54, s54, 256
    v_and_or_b32 v5, v0, 7, s54
    s_mov_b32 vcc_lo, 0x00ff0000
    s_mov_b32 vcc_hi, 0
    v_cndmask_b32 v4, v4, v5, vcc
    s_lshr_b32 s52, s48, 4
    s_lshl_b32 s52, s52, 1
    s_bfe_u32 s51, s48, 0x20002
    s_lshl_b32 s51, s51, 3
    s_add_u32 s52, s52, s51
    s_add_u32 s52, s52, 193
    v_writelane_b32 v4, s52, 24
    s_and_b32 s52, s48, 0x38
    s_mov_b32 exec_lo, 0
    v_and_or_b32 v4, v0, 7, s52
    v_bfe_u32 v5, v0, 3, 2
    v_lshl_or_b32 v4, v5, 6, v4
    s_mov_b32 exec_lo, -1
    v_mul_u32_u24 v4, 128, v4
    s_mov_b32 s54, 17338368
    s_mov_b32 s71, 0x40000
    L_gp45:
    buffer_load_dword v5, v4, s[12:15], s54 offen sc1
    s_sub_u32 s71, s71, 1
    s_cbranch_scc1 L_ge46
    s_waitcnt vmcnt(0)
    v_xor_b32 v5, s70, v5
    v_cmp_ne_u32 vcc, 0, v5
    s_cbranch_vccz L_ge46
    s_sleep 8
    s_branch L_gp45
    L_ge46:
    v_mov_b32 v4, 150384
    v_mov_b32 v5, 1
    s_mov_b64 exec, 1
    ds_write_b32 v4, v5 offset:0
    s_mov_b64 exec, -1
    L_op_n5:
    s_and_b32 s48, s2, 7
    s_lshl_b32 s48, s48, 3
    s_bfe_u32 s49, s2, 0x30003
    s_add_u32 s48, s48, s49
    s_lshr_b32 s51, s2, 6
    s_mul_i32 s49, s51, 5
    s_cmp_eq_u32 s51, 3
    s_subb_u32 s49, s49, 0
    s_and_b32 s50, s3, 3
    s_add_u32 s49, s49, s50
    s_lshl_b32 s52, s49, 4
    s_lshl_b32 s54, s49, 3
    s_lshl1_add_u32 s51, s49, 196
    s_cmp_lt_u32 s49, 14
    s_cselect_b32 s52, s52, s51
    s_cselect_b32 s51, 14, 6
    v_and_b32 v4, s51, v0
    s_cselect_b32 s51, 0, 2
    v_lshlrev_b32 v4, s51, v4
    v_and_or_b32 v4, v0, 1, v4
    v_add_u32 v4, s52, v4
    s_add_u32 s54, s54, 256
    v_and_or_b32 v5, v0, 7, s54
    s_mov_b32 vcc_lo, 0x00ff0000
    s_mov_b32 vcc_hi, 0
    v_cndmask_b32 v4, v4, v5, vcc
    s_lshr_b32 s52, s48, 4
    s_lshl_b32 s52, s52, 1
    s_bfe_u32 s51, s48, 0x20002
    s_lshl_b32 s51, s51, 3
    s_add_u32 s52, s52, s51
    s_add_u32 s52, s52, 193
    v_writelane_b32 v4, s52, 24
    v_mul_u32_u24 v4, 128, v4
    s_mov_b32 s54, 17338368
    s_mov_b32 s71, 0x40000
    L_gp47:
    buffer_load_dword v5, v4, s[12:15], s54 offen sc1
    s_sub_u32 s71, s71, 1
    s_cbranch_scc1 L_ge48
    s_waitcnt vmcnt(0)
    v_xor_b32 v5, s70, v5
    v_cmp_ne_u32 vcc, 0, v5
    s_cbranch_vccz L_ge48
    s_sleep 16
    s_branch L_gp47
    L_ge48:
    v_and_b32 v1, 3, v0
    v_bfe_u32 v2, v0, 2, 1
    v_lshl_or_b32 v1, v2, 4, v1
    v_bfe_u32 v2, v0, 3, 2
    v_lshl_or_b32 v1, v2, 2, v1
    v_lshlrev_b32 v1, 13, v1
    v_lshrrev_b32 v2, 5, v0
    v_lshl_or_b32 v1, v2, 4, v1
    v_and_b32 v61, 31, v0
    v_lshlrev_b32 v61, 3, v61
    s_lshl_b32 s52, s48, 8
    s_add_u32 s52, s52, 9543680
    s_lshl_b32 s51, s49, 18
    s_and_b32 s54, s48, 32
    s_lshl_b32 s54, s54, 6
    s_add_u32 s51, s51, s54
    s_and_b32 s54, s48, 30
    s_lshl_b32 s54, s54, 5
    s_add_u32 s51, s51, s54
    s_and_b32 s54, s48, 1
    s_lshl_b32 s54, s54, 10
    s_add_u32 s51, s51, s54
    s_add_u32 s51, s51, 11919360
    buffer_load_dword v60, v61, s[12:15], s52 offen sc1
    buffer_load_dwordx4 v[36:39], v1, s[12:15], s51 offen sc1
    buffer_load_dwordx4 v[40:43], v1, s[12:15], s51 offen offset:32 sc1
    s_add_u32 s51, s51, 4096
    buffer_load_dwordx4 v[44:47], v1, s[12:15], s51 offen sc1
    buffer_load_dwordx4 v[48:51], v1, s[12:15], s51 offen offset:32 sc1
    v_lshlrev_b32 v1, 4, v0
    s_lshl_b32 s52, s49, 10
    s_add_u32 s52, s52, 16637952
    s_lshl_b32 s54, s50, 13
    s_add_u32 s54, s54, 98304
    s_add_u32 s63, s52, 147456
    buffer_load_dwordx4 v[64:67], v1, s[12:15], s63 offen sc1
    s_add_u32 s63, s52, 165888
    buffer_load_dwordx4 v[68:71], v1, s[12:15], s63 offen sc1
    s_add_u32 s63, s52, 184320
    buffer_load_dwordx4 v[72:75], v1, s[12:15], s63 offen sc1
    s_add_u32 s63, s52, 202752
    buffer_load_dwordx4 v[76:79], v1, s[12:15], s63 offen sc1
    s_add_u32 s63, s52, 221184
    buffer_load_dwordx4 v[80:83], v1, s[12:15], s63 offen sc1
    s_add_u32 s63, s52, 239616
    buffer_load_dwordx4 v[84:87], v1, s[12:15], s63 offen sc1
    s_add_u32 s63, s52, 258048
    buffer_load_dwordx4 v[88:91], v1, s[12:15], s63 offen sc1
    s_add_u32 s63, s52, 294912
    buffer_load_dwordx4 v[92:95], v1, s[12:15], s63 offen sc1
    s_add_u32 s63, s52, 313344
    buffer_load_dwordx4 v[96:99], v1, s[12:15], s63 offen sc1
    s_add_u32 s63, s52, 331776
    buffer_load_dwordx4 v[100:103], v1, s[12:15], s63 offen sc1
    s_add_u32 s63, s52, 350208
    buffer_load_dwordx4 v[104:107], v1, s[12:15], s63 offen sc1
    s_add_u32 s63, s52, 368640
    buffer_load_dwordx4 v[108:111], v1, s[12:15], s63 offen sc1
    s_add_u32 s63, s52, 387072
    buffer_load_dwordx4 v[112:115], v1, s[12:15], s63 offen sc1
    s_add_u32 s63, s52, 405504
    buffer_load_dwordx4 v[116:119], v1, s[12:15], s63 offen sc1
    s_add_u32 s63, s52, 442368
    buffer_load_dwordx4 v[120:123], v1, s[12:15], s63 offen sc1
    s_add_u32 s63, s52, 460800
    buffer_load_dwordx4 v[124:127], v1, s[12:15], s63 offen sc1
    s_add_u32 s63, s52, 479232
    buffer_load_dwordx4 v[128:131], v1, s[12:15], s63 offen sc1
    s_add_u32 s63, s52, 497664
    buffer_load_dwordx4 v[132:135], v1, s[12:15], s63 offen sc1
    s_add_u32 s63, s52, 516096
    buffer_load_dwordx4 v[136:139], v1, s[12:15], s63 offen sc1
    s_add_u32 s63, s52, 534528
    buffer_load_dwordx4 v[140:143], v1, s[12:15], s63 offen sc1
    s_add_u32 s63, s52, 552960
    buffer_load_dwordx4 v[144:147], v1, s[12:15], s63 offen sc1
    v_bfe_u32 v62, v0, 1, 1
    v_lshlrev_b32 v62, 4, v62
    v_sub_u32 v62, 16, v62
    s_waitcnt vmcnt(21)
    v_lshrrev_b32 v60, v62, v60
    s_mov_b32 vcc_lo, 0x5
    s_mov_b32 vcc_hi, 0x500
    v_cndmask_b32 v52, 0, v60, vcc
    s_mov_b32 vcc_lo, 0x50
    s_mov_b32 vcc_hi, 0x5000
    v_cndmask_b32 v53, 0, v60, vcc
    s_mov_b32 vcc_lo, 0x50000
    s_mov_b32 vcc_hi, 0x5000000
    v_cndmask_b32 v54, 0, v60, vcc
    s_mov_b32 vcc_lo, 0x500000
    s_mov_b32 vcc_hi, 0x50000000
    v_cndmask_b32 v55, 0, v60, vcc
    s_mov_b32 vcc_lo, 0xa
    s_mov_b32 vcc_hi, 0xa00
    v_cndmask_b32 v56, 0, v60, vcc
    s_mov_b32 vcc_lo, 0xa0
    s_mov_b32 vcc_hi, 0xa000
    v_cndmask_b32 v57, 0, v60, vcc
    s_mov_b32 vcc_lo, 0xa0000
    s_mov_b32 vcc_hi, 0xa000000
    v_cndmask_b32 v58, 0, v60, vcc
    s_mov_b32 vcc_lo, 0xa00000
    s_mov_b32 vcc_hi, 0xa0000000
    v_cndmask_b32 v59, 0, v60, vcc
    s_nop 1
    v_mfma_f32_32x32x16_bf16 v[20:35], v[36:39], v[52:55], 0
    v_mfma_f32_32x32x16_bf16 v[20:35], v[40:43], v[56:59], v[20:35]
    v_mfma_f32_32x32x16_bf16 v[20:35], v[44:47], v[52:55], v[20:35]
    v_mfma_f32_32x32x16_bf16 v[20:35], v[48:51], v[56:59], v[20:35]
    s_add_u32 s63, s52, 0
    buffer_load_dwordx4 v[36:39], v1, s[12:15], s63 offen sc1
    s_add_u32 s63, s52, 18432
    buffer_load_dwordx4 v[40:43], v1, s[12:15], s63 offen sc1
    s_add_u32 s63, s52, 36864
    buffer_load_dwordx4 v[44:47], v1, s[12:15], s63 offen sc1
    s_add_u32 s63, s52, 55296
    buffer_load_dwordx4 v[48:51], v1, s[12:15], s63 offen sc1
    s_add_u32 s63, s52, 73728
    buffer_load_dwordx4 v[52:55], v1, s[12:15], s63 offen sc1
    s_add_u32 s63, s52, 92160
    buffer_load_dwordx4 v[56:59], v1, s[12:15], s63 offen sc1
    s_add_u32 s63, s52, 110592
    buffer_load_dwordx4 v[60:63], v1, s[12:15], s63 offen sc1
    s_mov_b32 s8, s42
    s_mov_b32 s9, s43
    s_mov_b32 s10, 2359296
    s_mov_b32 s11, 0x00020000
    s_lshl_b32 s55, s2, 4
    s_add_u32 s55, s55, s3
    s_cmp_lg_u32 s55, 11
    s_cbranch_scc1 L_op_noep
    v_mul_u32_u24 v148, 128, v0
    v_add_u32 v149, 8192, v148
    v_add_u32 v150, 16384, v148
    v_add_u32 v151, 24576, v148
    s_mov_b32 s55, 17338368
    s_mov_b32 s71, 0x40000
    L_gp49:
    buffer_load_dword v152, v148, s[12:15], s55 offen sc1
    buffer_load_dword v153, v149, s[12:15], s55 offen sc1
    buffer_load_dword v154, v150, s[12:15], s55 offen sc1
    buffer_load_dword v155, v151, s[12:15], s55 offen sc1
    s_sub_u32 s71, s71, 1
    s_cbranch_scc1 L_ge50
    s_waitcnt vmcnt(0)
    v_xor_b32 v152, s70, v152
    v_xor_b32 v153, s70, v153
    v_xor_b32 v154, s70, v154
    v_xor_b32 v155, s70, v155
    v_or_b32 v152, v152, v153
    v_or_b32 v152, v152, v154
    v_or_b32 v152, v152, v155
    v_cmp_ne_u32 vcc, 0, v152
    s_cbranch_vccz L_ge50
    s_sleep 16
    s_branch L_gp49
    L_ge50:
    s_mov_b32 s55, 17651712
    v_mov_b32 v148, s70
    v_lshlrev_b32 v149, 2, v0
    s_mov_b32 exec_hi, 0
    buffer_store_dword v148, v149, s[12:15], s55 offen sc1
    s_mov_b64 exec, -1
    L_op_noep:
    v_mov_b32 v150, v0
    v_lshrrev_b32 v3, 5, v0
    v_and_b32 v2, 31, v0
    v_and_b32 v165, 3, v0
    v_lshlrev_b32 v165, 2, v165
    v_add_u32 v165, 148784, v165
    v_lshlrev_b32 v0, 9, v3
    v_lshl_add_u32 v0, v2, 2, v0
    v_add_u32 v0, 73728, v0
    v_mul_u32_u24 v2, 80, v2
    v_lshl_add_u32 v2, v3, 5, v2
    v_add_u32 v2, s54, v2
    v_add_u32 v3, s54, v1
    s_mul_i32 s53, s48, 36864
    s_lshl_b32 s56, s49, 6
    s_add_u32 s53, s53, s56
    s_mov_b32 m0, s54
    s_mov_b32 s56, 15
    v_bfe_u32 v148, v150, 2, 1
    v_mul_u32_u24 v148, 304, v148
    v_and_b32 v149, 7, v150
    v_lshl_add_u32 v148, v149, 2, v148
    v_add_u32 v148, 149744, v148
    s_mov_b32 s71, 0x100000
    L_pg51:
    ds_read_b32 v149, v148
    s_sub_u32 s71, s71, 1
    s_cbranch_scc1 L_pe52
    s_waitcnt lgkmcnt(0)
    v_cmp_eq_u32 vcc, 0, v149
    s_cbranch_vccz L_pe52
    s_sleep 12
    s_branch L_pg51
    L_pe52:
    s_add_u32 s63, s52, 589824
    buffer_load_dwordx4 v1, s[12:15], s63 offen sc1 lds
    s_add_u32 m0, m0, 1024
    s_add_u32 s63, s52, 129024
    buffer_load_dwordx4 v1, s[12:15], s63 offen sc1 lds
    s_add_u32 m0, m0, 1024
    s_add_u32 s63, s52, 608256
    buffer_load_dwordx4 v1, s[12:15], s63 offen sc1 lds
    s_add_u32 m0, m0, 1024
    s_add_u32 s63, s52, 276480
    buffer_load_dwordx4 v1, s[12:15], s63 offen sc1 lds
    s_add_u32 m0, m0, 1024
    s_add_u32 s63, s52, 626688
    buffer_load_dwordx4 v1, s[12:15], s63 offen sc1 lds
    s_add_u32 m0, m0, 1024
    s_add_u32 s63, s52, 423936
    buffer_load_dwordx4 v1, s[12:15], s63 offen sc1 lds
    s_add_u32 m0, m0, 1024
    s_add_u32 s63, s52, 645120
    buffer_load_dwordx4 v1, s[12:15], s63 offen sc1 lds
    s_add_u32 m0, m0, 1024
    s_add_u32 s63, s52, 571392
    buffer_load_dwordx4 v1, s[12:15], s63 offen sc1 lds
    s_add_u32 m0, m0, 1024
    v_add_u32 v1, 40960, v1
    s_mov_b32 s71, 0x400000
    s_setprio 0
    s_waitcnt vmcnt(0)
    L_op_poll:
    ds_read_b32 v164, v165
    s_sub_u32 s71, s71, 1
    s_cselect_b32 s57, 15, 0
    s_cselect_b32 s71, 0, s71
    s_waitcnt lgkmcnt(0)
    v_cmp_ne_u32 vcc, 0, v164
    s_or_b32 s57, s57, vcc_lo
    s_and_b32 s57, s57, s56
    s_cbranch_scc0 L_op_poll
    s_ff1_i32_b32 s58, s57
    s_lshl_b32 s59, s58, 13
    v_add_u32 v167, s59, v1
    ds_read_b128 v[148:151], v167 offset:0
    ds_read_b128 v[152:155], v167 offset:1024
    ds_read_b128 v[156:159], v167 offset:2048
    ds_read_b128 v[160:163], v167 offset:3072
    L_op_disp:
    s_cmp_eq_u32 s58, 0
    s_cbranch_scc1 L_op_q0
    s_cmp_eq_u32 s58, 1
    s_cbranch_scc1 L_op_q1
    s_cmp_eq_u32 s58, 2
    s_cbranch_scc1 L_op_q2
    L_op_q3:
    ds_read_b32 v164, v165
    v_add_u32 v166, 3072, v0
    s_bitset0_b32 s56, 3
    s_waitcnt lgkmcnt(4)
    v_mfma_f32_32x32x16_bf16 v[4:19], v[120:123], v[148:151], 0
    ds_read_b128 v[148:151], v1 offset:28672
    s_waitcnt lgkmcnt(4)
    v_mfma_f32_32x32x16_bf16 v[4:19], v[124:127], v[152:155], v[4:19]
    ds_read_b128 v[152:155], v1 offset:29696
    s_waitcnt lgkmcnt(4)
    v_mfma_f32_32x32x16_bf16 v[4:19], v[128:131], v[156:159], v[4:19]
    ds_read_b128 v[156:159], v1 offset:30720
    ds_read_b128 v[120:123], v3 offset:6144
    ds_read_b128 v[128:131], v3 offset:7168
    ds_read2_b32 v[124:125], v166 offset0:0 offset1:32
    ds_read2_b32 v[126:127], v166 offset0:64 offset1:96
    s_waitcnt lgkmcnt(8)
    v_mfma_f32_32x32x16_bf16 v[4:19], v[132:135], v[160:163], v[4:19]
    ds_read_b128 v[160:163], v1 offset:31744
    s_waitcnt lgkmcnt(7)
    v_cmp_ne_u32 vcc, 0, v164
    v_mfma_f32_32x32x16_bf16 v[4:19], v[136:139], v[148:151], v[4:19]
    s_and_b32 s57, vcc_lo, s56
    s_ff1_i32_b32 s58, s57
    s_lshl_b32 s59, s58, 13
    v_add_u32 v167, s59, v1
    ds_read_b128 v[148:151], v167
    s_waitcnt lgkmcnt(7)
    v_mfma_f32_32x32x16_bf16 v[4:19], v[140:143], v[152:155], v[4:19]
    ds_read_b128 v[152:155], v167 offset:1024
    s_waitcnt lgkmcnt(7)
    v_mfma_f32_32x32x16_bf16 v[4:19], v[144:147], v[156:159], v[4:19]
    ds_read_b128 v[156:159], v167 offset:2048
    s_waitcnt lgkmcnt(3)
    v_mfma_f32_32x32x16_bf16 v[4:19], v[128:131], v[160:163], v[4:19]
    ds_read_b128 v[160:163], v167 offset:3072
    s_cmp_lg_u32 s57, 0
    v_mfma_f32_32x32x16_bf16 v[132:147], v[120:123], v[124:127], v[4:19]
    s_cbranch_scc1 L_op_disp
    s_cmp_lg_u32 s56, 0
    s_cbranch_scc1 L_op_poll
    s_branch L_op_fin
    L_op_q0:
    ds_read_b32 v164, v165
    v_add_u32 v166, 0, v0
    s_bitset0_b32 s56, 0
    s_waitcnt lgkmcnt(4)
    v_mfma_f32_32x32x16_bf16 v[4:19], v[36:39], v[148:151], v[20:35]
    ds_read_b128 v[148:151], v1 offset:4096
    s_waitcnt lgkmcnt(4)
    v_mfma_f32_32x32x16_bf16 v[4:19], v[40:43], v[152:155], v[4:19]
    ds_read_b128 v[152:155], v1 offset:5120
    s_waitcnt lgkmcnt(4)
    v_mfma_f32_32x32x16_bf16 v[4:19], v[44:47], v[156:159], v[4:19]
    ds_read_b128 v[156:159], v1 offset:6144
    ds_read_b128 v[36:39], v3 offset:0
    ds_read_b128 v[44:47], v3 offset:1024
    ds_read2_b32 v[40:41], v166 offset0:0 offset1:32
    ds_read2_b32 v[42:43], v166 offset0:64 offset1:96
    s_waitcnt lgkmcnt(8)
    v_mfma_f32_32x32x16_bf16 v[4:19], v[48:51], v[160:163], v[4:19]
    ds_read_b128 v[160:163], v1 offset:7168
    s_waitcnt lgkmcnt(7)
    v_cmp_ne_u32 vcc, 0, v164
    v_mfma_f32_32x32x16_bf16 v[4:19], v[52:55], v[148:151], v[4:19]
    s_and_b32 s57, vcc_lo, s56
    s_ff1_i32_b32 s58, s57
    s_lshl_b32 s59, s58, 13
    v_add_u32 v167, s59, v1
    ds_read_b128 v[148:151], v167
    s_waitcnt lgkmcnt(7)
    v_mfma_f32_32x32x16_bf16 v[4:19], v[56:59], v[152:155], v[4:19]
    ds_read_b128 v[152:155], v167 offset:1024
    s_waitcnt lgkmcnt(7)
    v_mfma_f32_32x32x16_bf16 v[4:19], v[60:63], v[156:159], v[4:19]
    ds_read_b128 v[156:159], v167 offset:2048
    s_waitcnt lgkmcnt(3)
    v_mfma_f32_32x32x16_bf16 v[4:19], v[44:47], v[160:163], v[4:19]
    ds_read_b128 v[160:163], v167 offset:3072
    s_cmp_lg_u32 s57, 0
    v_mfma_f32_32x32x16_bf16 v[48:63], v[36:39], v[40:43], v[4:19]
    s_cbranch_scc1 L_op_disp
    s_cmp_lg_u32 s56, 0
    s_cbranch_scc1 L_op_poll
    s_branch L_op_fin
    L_op_q1:
    ds_read_b32 v164, v165
    v_add_u32 v166, 1024, v0
    s_bitset0_b32 s56, 1
    s_waitcnt lgkmcnt(4)
    v_mfma_f32_32x32x16_bf16 v[4:19], v[64:67], v[148:151], 0
    ds_read_b128 v[148:151], v1 offset:12288
    s_waitcnt lgkmcnt(4)
    v_mfma_f32_32x32x16_bf16 v[4:19], v[68:71], v[152:155], v[4:19]
    ds_read_b128 v[152:155], v1 offset:13312
    s_waitcnt lgkmcnt(4)
    v_mfma_f32_32x32x16_bf16 v[4:19], v[72:75], v[156:159], v[4:19]
    ds_read_b128 v[156:159], v1 offset:14336
    ds_read_b128 v[64:67], v3 offset:2048
    ds_read_b128 v[72:75], v3 offset:3072
    ds_read2_b32 v[68:69], v166 offset0:0 offset1:32
    ds_read2_b32 v[70:71], v166 offset0:64 offset1:96
    s_waitcnt lgkmcnt(8)
    v_mfma_f32_32x32x16_bf16 v[4:19], v[76:79], v[160:163], v[4:19]
    ds_read_b128 v[160:163], v1 offset:15360
    s_waitcnt lgkmcnt(7)
    v_cmp_ne_u32 vcc, 0, v164
    v_mfma_f32_32x32x16_bf16 v[4:19], v[80:83], v[148:151], v[4:19]
    s_and_b32 s57, vcc_lo, s56
    s_ff1_i32_b32 s58, s57
    s_lshl_b32 s59, s58, 13
    v_add_u32 v167, s59, v1
    ds_read_b128 v[148:151], v167
    s_waitcnt lgkmcnt(7)
    v_mfma_f32_32x32x16_bf16 v[4:19], v[84:87], v[152:155], v[4:19]
    ds_read_b128 v[152:155], v167 offset:1024
    s_waitcnt lgkmcnt(7)
    v_mfma_f32_32x32x16_bf16 v[4:19], v[88:91], v[156:159], v[4:19]
    ds_read_b128 v[156:159], v167 offset:2048
    s_waitcnt lgkmcnt(3)
    v_mfma_f32_32x32x16_bf16 v[4:19], v[72:75], v[160:163], v[4:19]
    ds_read_b128 v[160:163], v167 offset:3072
    s_cmp_lg_u32 s57, 0
    v_mfma_f32_32x32x16_bf16 v[76:91], v[64:67], v[68:71], v[4:19]
    s_cbranch_scc1 L_op_disp
    s_cmp_lg_u32 s56, 0
    s_cbranch_scc1 L_op_poll
    s_branch L_op_fin
    L_op_q2:
    ds_read_b32 v164, v165
    v_add_u32 v166, 2048, v0
    s_bitset0_b32 s56, 2
    s_waitcnt lgkmcnt(4)
    v_mfma_f32_32x32x16_bf16 v[4:19], v[92:95], v[148:151], 0
    ds_read_b128 v[148:151], v1 offset:20480
    s_waitcnt lgkmcnt(4)
    v_mfma_f32_32x32x16_bf16 v[4:19], v[96:99], v[152:155], v[4:19]
    ds_read_b128 v[152:155], v1 offset:21504
    s_waitcnt lgkmcnt(4)
    v_mfma_f32_32x32x16_bf16 v[4:19], v[100:103], v[156:159], v[4:19]
    ds_read_b128 v[156:159], v1 offset:22528
    ds_read_b128 v[92:95], v3 offset:4096
    ds_read_b128 v[100:103], v3 offset:5120
    ds_read2_b32 v[96:97], v166 offset0:0 offset1:32
    ds_read2_b32 v[98:99], v166 offset0:64 offset1:96
    s_waitcnt lgkmcnt(8)
    v_mfma_f32_32x32x16_bf16 v[4:19], v[104:107], v[160:163], v[4:19]
    ds_read_b128 v[160:163], v1 offset:23552
    s_waitcnt lgkmcnt(7)
    v_cmp_ne_u32 vcc, 0, v164
    v_mfma_f32_32x32x16_bf16 v[4:19], v[108:111], v[148:151], v[4:19]
    s_and_b32 s57, vcc_lo, s56
    s_ff1_i32_b32 s58, s57
    s_lshl_b32 s59, s58, 13
    v_add_u32 v167, s59, v1
    ds_read_b128 v[148:151], v167
    s_waitcnt lgkmcnt(7)
    v_mfma_f32_32x32x16_bf16 v[4:19], v[112:115], v[152:155], v[4:19]
    ds_read_b128 v[152:155], v167 offset:1024
    s_waitcnt lgkmcnt(7)
    v_mfma_f32_32x32x16_bf16 v[4:19], v[116:119], v[156:159], v[4:19]
    ds_read_b128 v[156:159], v167 offset:2048
    s_waitcnt lgkmcnt(3)
    v_mfma_f32_32x32x16_bf16 v[4:19], v[100:103], v[160:163], v[4:19]
    ds_read_b128 v[160:163], v167 offset:3072
    s_cmp_lg_u32 s57, 0
    v_mfma_f32_32x32x16_bf16 v[104:119], v[92:95], v[96:99], v[4:19]
    s_cbranch_scc1 L_op_disp
    s_cmp_lg_u32 s56, 0
    s_cbranch_scc1 L_op_poll
    L_op_fin:
    v_subrev_u32 v164, s54, v3
    v_lshrrev_b32 v165, 6, v164
    v_and_b32 v164, 48, v164
    v_mul_u32_u24 v166, 80, v165
    v_add3_u32 v166, v166, v164, s54
    v_mul_u32_u24 v167, 1152, v165
    v_add_u32 v167, v167, v164
    s_nop 1
    v_pk_add_f32 v[48:49], v[48:49], v[76:77]
    v_pk_add_f32 v[104:105], v[104:105], v[132:133]
    v_pk_add_f32 v[50:51], v[50:51], v[78:79]
    v_pk_add_f32 v[106:107], v[106:107], v[134:135]
    v_pk_add_f32 v[52:53], v[52:53], v[80:81]
    v_pk_add_f32 v[108:109], v[108:109], v[136:137]
    v_pk_add_f32 v[54:55], v[54:55], v[82:83]
    v_pk_add_f32 v[110:111], v[110:111], v[138:139]
    v_pk_add_f32 v[48:49], v[48:49], v[104:105]
    v_pk_add_f32 v[50:51], v[50:51], v[106:107]
    v_pk_add_f32 v[52:53], v[52:53], v[108:109]
    v_pk_add_f32 v[54:55], v[54:55], v[110:111]
    v_cvt_pk_bf16_f32 v20, v48, v49
    v_cvt_pk_bf16_f32 v21, v50, v51
    v_cvt_pk_bf16_f32 v22, v52, v53
    v_cvt_pk_bf16_f32 v23, v54, v55
    ds_write_b128 v2, v[20:23] offset:0
    v_pk_add_f32 v[56:57], v[56:57], v[84:85]
    v_pk_add_f32 v[112:113], v[112:113], v[140:141]
    v_pk_add_f32 v[58:59], v[58:59], v[86:87]
    v_pk_add_f32 v[114:115], v[114:115], v[142:143]
    v_pk_add_f32 v[60:61], v[60:61], v[88:89]
    v_pk_add_f32 v[116:117], v[116:117], v[144:145]
    v_pk_add_f32 v[62:63], v[62:63], v[90:91]
    v_pk_add_f32 v[118:119], v[118:119], v[146:147]
    v_pk_add_f32 v[56:57], v[56:57], v[112:113]
    v_pk_add_f32 v[58:59], v[58:59], v[114:115]
    v_pk_add_f32 v[60:61], v[60:61], v[116:117]
    v_pk_add_f32 v[62:63], v[62:63], v[118:119]
    v_cvt_pk_bf16_f32 v24, v56, v57
    v_cvt_pk_bf16_f32 v25, v58, v59
    v_cvt_pk_bf16_f32 v26, v60, v61
    v_cvt_pk_bf16_f32 v27, v62, v63
    ds_write_b128 v2, v[24:27] offset:16
    ds_read_b128 v[4:7], v166
    ds_read_b128 v[8:11], v166 offset:1280
    s_add_u32 s57, s53, 18432
    s_waitcnt lgkmcnt(1)
    buffer_store_dwordx4 v[4:7], v167, s[8:11], s53 offen sc1
    s_waitcnt lgkmcnt(0)
    buffer_store_dwordx4 v[8:11], v167, s[8:11], s57 offen sc1
L_end:
    s_endpgm
    L_exit:
    s_endpgm
.p2align 4
.type kgen_tab,@object
kgen_tab:
    .long 0, 128, 124, 11376, 272, 2304, 112, 11408
    .long 544, 4480, 116, 11440, 816, 6656, 120, 11472
    .long 2448, 400, 0, 9824, 2448, 2576, 4, 9856
    .long 2720, 4752, 8, 9888, 2992, 6928, 12, 9920
    .long 1088, 672, 16, 8272, 1360, 2848, 20, 8304
    .long 1632, 5024, 24, 8336, 1904, 7200, 28, 8368
    .long 2992, 944, 32, 6720, 2992, 3120, 36, 6752
    .long 3264, 5296, 40, 6784, 3536, 7472, 44, 6816
    .long 3808, 1216, 48, 5168, 4080, 3392, 52, 5200
    .long 4352, 5568, 56, 5232, 4352, 7744, 60, 5264
    .long 4624, 1488, 64, 3616, 4896, 3664, 68, 3648
    .long 5168, 5840, 72, 3680, 5168, 8016, 76, 3712
    .long 5440, 1760, 80, 2064, 5712, 3936, 84, 2096
    .long 5984, 6112, 88, 2128, 6256, 7616, 92, 2160
    .long 6528, 2032, 96, 512, 6800, 4208, 100, 544
    .long 7072, 6384, 104, 576, 7344, 7888, 108, 608
    .long 16, 144, 124, 11376, 288, 2320, 240, 11408
    .long 560, 4496, 244, 11440, 832, 6672, 248, 11472
    .long 2464, 416, 128, 9824, 2464, 2592, 132, 9856
    .long 2736, 4768, 136, 9888, 3008, 6944, 140, 9920
    .long 1104, 688, 144, 8272, 1376, 2864, 148, 8304
    .long 1648, 5040, 152, 8336, 1920, 7216, 156, 8368
    .long 3008, 960, 160, 6720, 3008, 3136, 164, 6752
    .long 3280, 5312, 168, 6784, 3552, 7488, 172, 6816
    .long 3824, 1232, 176, 5168, 4096, 3408, 180, 5200
    .long 4368, 5584, 184, 5232, 4368, 7760, 188, 5264
    .long 4640, 1504, 192, 3616, 4912, 3680, 196, 3648
    .long 5184, 5856, 200, 3680, 5184, 8032, 204, 3712
    .long 5456, 1776, 208, 2064, 5728, 3952, 212, 2096
    .long 6000, 6128, 216, 2128, 6272, 7632, 220, 2160
    .long 6544, 2048, 224, 512, 6816, 4224, 228, 544
    .long 7088, 6400, 232, 576, 7360, 7904, 236, 608
.size kgen_tab, 1024
.type code_pad,@object
code_pad:
.fill (40960 - (code_pad - gated_mix__ssm_conv_s4__mha_block__prompt_kernel)) / 4, 4, 0
.size code_pad, . - code_pad
.section .rodata,"a"
.p2align 6
.amdhsa_kernel gated_mix__ssm_conv_s4__mha_block__prompt_kernel
  .amdhsa_next_free_vgpr 168
  .amdhsa_next_free_sgpr 102
  .amdhsa_accum_offset 168
  .amdhsa_group_segment_fixed_size 0
  .amdhsa_kernarg_size 128
  .amdhsa_user_sgpr_count 2
  .amdhsa_user_sgpr_kernarg_segment_ptr 1
  .amdhsa_system_sgpr_workgroup_id_x 1
.end_amdhsa_kernel
```
